```python
import torch

def _softmax(x, axis=-1):
    return torch.softmax(x, dim=axis)
def _gelu(x):
    return torch.nn.functional.gelu(x, approximate="tanh")
def _silu(x):
    return torch.nn.functional.silu(x)
def _sigmoid(x):
    return torch.sigmoid(x)
def _layernorm(x, axis=-1, eps=1e-5):
    m = x.mean(dim=axis, keepdim=True)
    v = x.var(dim=axis, keepdim=True, unbiased=False)
    return (x - m) / torch.sqrt(v + eps)
def _scatter_add(tgt, idx, src, axis=0):
    return tgt.clone().index_add_(axis, idx, src)
def _segment_sum(src, seg, n):
    out = torch.zeros((n,) + src.shape[1:], dtype=src.dtype)
    return out.index_add_(0, seg, src)
def _pad(x, pw):
    flat = tuple(v for pair in reversed(pw) for v in pair)
    return torch.nn.functional.pad(x, flat)

kernel_name = 'recurrent_scan__ssm_conv_s4d__dense_activation_gelu__prompt'

def setup_inputs():

    _w = (lambda a: (lambda t: t.to(torch.bfloat16) if t.is_floating_point() else t)(torch.as_tensor(a)))
    def _A_setup():
        Bsz, L, D, N = 1, 2048, 640, 128
        return {
            "u": _w((lambda *s: torch.randn(*s, dtype=torch.bfloat16) * 0.05)(Bsz, L, D)),
            "log_A_real": _w((lambda *s: torch.randn(*s, dtype=torch.bfloat16) * 6.4)(D, N) * 0.5),
            "A_imag": _w((lambda *s: torch.randn(*s, dtype=torch.bfloat16) * 0.2)(D, N) * 3.14),
            "C_real": _w((lambda *s: torch.randn(*s, dtype=torch.bfloat16) * 0.4)(D, N) / N ** 0.5),
            "C_imag": _w((lambda *s: torch.randn(*s, dtype=torch.bfloat16) * 0.4)(D, N) / N ** 0.5),
            "log_dt": _w((lambda *s: torch.randn(*s, dtype=torch.bfloat16) * 0.2)(D) * 0.5 - 4.0),
            "D_skip": _w((lambda *s: torch.randn(*s, dtype=torch.bfloat16) * 0.2)(D)),
        }
    _A_in = _A_setup()

    def _B_setup():
        B, S, D, F = 1, 2048, 640, 1728
        return {
            "x": _w((lambda *s: torch.randn(*s, dtype=torch.bfloat16) * 0.05)(B, S, D)),
            "w1": _w((lambda *s: torch.randn(*s, dtype=torch.bfloat16) * 0.8)(D, F) * (D ** -0.5)),
            "b1": _w((lambda *s: torch.randn(*s, dtype=torch.bfloat16) * 0.1)(F) * 0.01),
            "w2": _w((lambda *s: torch.randn(*s, dtype=torch.bfloat16) * 0.1)(F, D) * (F ** -0.5)),
            "b2": _w((lambda *s: torch.randn(*s, dtype=torch.bfloat16) * 0.1)(D) * 0.01),
        }
    _B_in = _B_setup()

    return {
        "A_u": _A_in["u"],
        "A_log_A_real": _A_in["log_A_real"],
        "A_A_imag": _A_in["A_imag"],
        "A_C_real": _A_in["C_real"],
        "A_C_imag": _A_in["C_imag"],
        "A_log_dt": _A_in["log_dt"],
        "A_D_skip": _A_in["D_skip"],
        "B_x": _B_in["x"],
        "B_w1": _B_in["w1"],
        "B_b1": _B_in["b1"],
        "B_w2": _B_in["w2"],
        "B_b2": _B_in["b2"],
    }

def reference(A_u, A_log_A_real, A_A_imag, A_C_real, A_C_imag, A_log_dt, A_D_skip, B_x, B_w1, B_b1, B_w2, B_b2):
    def _A_ref(u, log_A_real, A_imag, C_real, C_imag, log_dt, D_skip):
        L = u.shape[1]
        dt = torch.exp(log_dt)
        A = -torch.exp(log_A_real) + 1j * A_imag
        C = (C_real + 1j * C_imag) * dt[:, None]
        pos = (lambda x, dt: x.to(dt))(torch.arange(L), log_dt.dtype)
        P = torch.exp((A * dt[:, None])[:, :, None] * pos[None, None, :])
        K = 2.0 * torch.einsum("dn,dnl->dl", C, P).real
        L2 = 2 * L
        u_t = (lambda x, *d: x.permute(*d))(u, 0, 2, 1)
        Kf = (lambda x, *a, **k: torch.fft.rfft(x.float(), *a, **k))(K, L2)
        Uf = (lambda x, *a, **k: torch.fft.rfft(x.float(), *a, **k))(u_t, L2)
        y = (lambda x, *a, **k: torch.fft.irfft(x, *a, **k).to(torch.bfloat16))(Uf * Kf[None, :, :], L2)[:, :, :L]
        y = (lambda x, *d: x.permute(*d))(y, 0, 2, 1)
        return y + u * D_skip[None, None, :]

    def _B_ref(x, w1, b1, w2, b2):
        h = torch.einsum("bsd,df->bsf", x, w1) + b1
        h = _gelu(h)
        return torch.einsum("bsf,fd->bsd", h, w2) + b2

    x = A_u
    xn = _layernorm(x, axis=-1)
    s = _A_ref(xn, A_log_A_real, A_A_imag, A_C_real, A_C_imag, A_log_dt, A_D_skip)
    g = _silu(_B_ref(xn, B_w1, B_b1, B_w2, B_b2))
    return x + s * g
```

```asm
; @launch grid=(512,1,1) block=(256,1,1) lds=81920
.amdgcn_target "amdgcn-amd-amdhsa--gfx950"
.text
.globl recurrent_scan__ssm_conv_s4d__dense_activation_gelu__prompt_kernel
.p2align 8
.type recurrent_scan__ssm_conv_s4d__dense_activation_gelu__prompt_kernel,@function
recurrent_scan__ssm_conv_s4d__dense_activation_gelu__prompt_kernel:
  s_cmp_ge_u32 s2, 512
  s_cbranch_scc1 L_exit
  s_load_dwordx16 s[64:79], s[0:1], 0
  s_load_dwordx8 s[80:87], s[0:1], 64
  s_load_dwordx4 s[88:91], s[0:1], 96
  s_load_dwordx2 s[92:93], s[0:1], 112
  v_lshrrev_b32 v1, 6, v0
  v_and_b32 v2, 63, v0
  v_readfirstlane_b32 s32, v1
  s_and_b32 s62, s2, 255
  s_cmp_ge_u32 s62, 224
  s_cbranch_scc1 L_LN
  s_cmp_ge_u32 s2, 256
  s_cbranch_scc1 L_S
  s_and_b32 s35, s2, 7
  s_lshr_b32 s36, s2, 3
  s_lshr_b32 s33, s35, 1
  s_lshl_b32 s33, s33, 2
  s_and_b32 s34, s36, 3
  s_add_u32 s33, s33, s34
  s_and_b32 s34, s35, 1
  s_mul_i32 s34, s34, 7
  s_lshr_b32 s36, s36, 2
  s_add_u32 s34, s34, s36
  v_lshrrev_b32 v3, 4, v2
  v_and_b32 v4, 15, v2
  v_lshlrev_b32 v5, 2, v3
  v_xor_b32 v4, v4, v5
  v_mul_u32_u24 v3, 3456, v3
  v_lshl_add_u32 v10, v4, 4, v3
  v_add_u32 v11, 12800, v10
  v_lshrrev_b32 v3, 2, v2
  v_and_b32 v4, 3, v2
  v_lshrrev_b32 v5, 4, v2
  v_xor_b32 v4, v4, v5
  v_mul_u32_u24 v3, 1280, v3
  v_lshl_add_u32 v12, v4, 4, v3
  v_add_u32 v13, 19456, v12
  s_lshl_b32 s40, s34, 8
  s_mul_i32 s38, s32, 27648
  s_add_u32 s40, s40, s38
  s_lshl_b32 s41, s33, 7
  s_lshl_b32 s38, s32, 5
  s_add_u32 s41, s41, s38
  s_mul_i32 s41, s41, 1280
  s_lshl_b32 s42, s32, 11
  s_add_u32 s43, s42, 8192
  s_waitcnt lgkmcnt(0)
  s_mov_b32 s12, s80
  s_mov_b32 s13, s81
  s_mov_b32 s14, 2211840
  s_mov_b32 s15, 0x00020000
  s_mov_b32 s8, s64
  s_mov_b32 s9, s65
  s_mov_b32 s10, 2621440
  s_mov_b32 s11, 0x00020000
  s_and_b32 s46, s33, 3
  s_mul_i32 s46, s46, 5
  s_cmp_ge_u32 s34, 7
  s_cselect_b32 s47, 7, 0
  s_sub_u32 s47, s34, s47
  s_mul_i32 s47, s47, 3
  s_add_u32 s46, s46, s47
  s_cmp_ge_u32 s46, 20
  s_cselect_b32 s47, 20, 0
  s_sub_u32 s46, s46, s47
  s_sub_u32 s51, 20, s46
  s_mul_i32 s47, s46, 110592
  s_add_u32 s40, s40, s47
  s_sub_u32 s49, s40, 2211840
  s_lshl_b32 s47, s46, 6
  s_add_u32 s41, s41, s47
  s_sub_u32 s50, s41, 1280
  s_cmp_le_u32 s51, 0
  s_cselect_b32 s38, s49, s40
  s_cselect_b32 s39, s50, s41
  s_add_u32 s38, s38, 0
  s_add_u32 s39, s39, 0
  s_add_u32 m0, s42, 0
  s_nop 0
  buffer_load_dwordx4 v10, s[12:15], s38 offen lds
  buffer_load_dwordx4 v11, s[12:15], s38 offen offset:1024 lds
  s_add_u32 m0, s43, 0
  s_nop 0
  buffer_load_dwordx4 v12, s[8:11], s39 offen lds
  buffer_load_dwordx4 v13, s[8:11], s39 offen offset:1024 lds
  s_cmp_le_u32 s51, 1
  s_cselect_b32 s38, s49, s40
  s_cselect_b32 s39, s50, s41
  s_add_u32 s38, s38, 110592
  s_add_u32 s39, s39, 64
  s_add_u32 m0, s42, 16384
  s_nop 0
  buffer_load_dwordx4 v10, s[12:15], s38 offen lds
  buffer_load_dwordx4 v11, s[12:15], s38 offen offset:1024 lds
  s_add_u32 m0, s43, 16384
  s_nop 0
  buffer_load_dwordx4 v12, s[8:11], s39 offen lds
  buffer_load_dwordx4 v13, s[8:11], s39 offen offset:1024 lds
  v_bfe_u32 v3, v2, 2, 2
  v_lshrrev_b32 v4, 5, v2
  v_lshl_add_u32 v5, v4, 3, v3
  v_lshlrev_b32 v5, 8, v5
  v_bfe_u32 v6, v2, 4, 1
  v_lshlrev_b32 v6, 5, v6
  v_and_b32 v7, 3, v2
  v_lshl_add_u32 v6, v7, 3, v6
  v_add_u32 v5, v5, v6
  s_and_b32 s38, s32, 1
  s_lshl_b32 s38, s38, 1
  s_lshr_b32 s46, s32, 1
  s_xor_b32 s39, s46, 0
  s_add_u32 s39, s38, s39
  v_xor_b32 v7, s39, v3
  v_lshl_add_u32 v14, v7, 6, v5
  s_xor_b32 s39, s46, 1
  s_add_u32 s39, s38, s39
  v_xor_b32 v7, s39, v3
  v_lshl_add_u32 v15, v7, 6, v5
  v_and_b32 v3, 31, v2
  s_lshr_b32 s38, s32, 1
  s_lshl_b32 s38, s38, 6
  v_add_u32 v5, s38, v3
  v_lshlrev_b32 v5, 6, v5
  v_bfe_u32 v6, v2, 2, 2
  v_xor_b32 v7, v4, v6
  v_lshl_add_u32 v16, v7, 4, v5
  v_xor_b32 v7, 2, v7
  v_lshl_add_u32 v17, v7, 4, v5
  v_add_u32 v16, 8192, v16
  v_add_u32 v17, 8192, v17
  v_add_u32 v18, 49152, v14
  v_add_u32 v20, 49152, v16
  v_add_u32 v19, 49152, v15
  v_add_u32 v21, 49152, v17
  s_cmp_le_u32 s51, 2
  s_cselect_b32 s38, s49, s40
  s_cselect_b32 s39, s50, s41
  s_add_u32 s38, s38, 221184
  s_add_u32 s39, s39, 128
  s_add_u32 m0, s42, 32768
  s_nop 0
  buffer_load_dwordx4 v10, s[12:15], s38 offen lds
  buffer_load_dwordx4 v11, s[12:15], s38 offen offset:1024 lds
  s_add_u32 m0, s43, 32768
  s_nop 0
  buffer_load_dwordx4 v12, s[8:11], s39 offen lds
  buffer_load_dwordx4 v13, s[8:11], s39 offen offset:1024 lds
  s_cmp_le_u32 s51, 3
  s_cselect_b32 s38, s49, s40
  s_cselect_b32 s39, s50, s41
  s_add_u32 s38, s38, 331776
  s_add_u32 s39, s39, 192
  s_add_u32 m0, s42, 49152
  s_nop 0
  buffer_load_dwordx4 v10, s[12:15], s38 offen lds
  buffer_load_dwordx4 v11, s[12:15], s38 offen offset:1024 lds
  s_add_u32 m0, s43, 49152
  s_nop 0
  buffer_load_dwordx4 v12, s[8:11], s39 offen lds
  buffer_load_dwordx4 v13, s[8:11], s39 offen offset:1024 lds
  s_mov_b32 s16, s92
  s_mov_b32 s17, s93
  s_mov_b32 s18, 7077888
  s_mov_b32 s19, 0x00020000
  s_add_u32 s20, s92, 19922944
  s_addc_u32 s21, s93, 0
  s_mov_b32 s22, 16384
  s_mov_b32 s23, 0x00020000
  s_mov_b32 s24, s82
  s_mov_b32 s25, s83
  s_mov_b32 s26, 3456
  s_mov_b32 s27, 0x00020000
  s_mov_b32 s28, s90
  s_mov_b32 s29, s91
  s_mov_b32 s30, 256
  s_mov_b32 s31, 0x00020000
  s_add_u32 s4, s92, 20185088
  s_addc_u32 s5, s93, 0
  s_mov_b32 s6, 16384
  s_mov_b32 s7, 0x00020000
  v_mov_b32 v164, 0x3f803f80
  v_mov_b32 v165, 0x3f803f80
  v_mov_b32 v166, 0x3f803f80
  v_mov_b32 v167, 0x3f803f80
  s_waitcnt vmcnt(12)
  s_barrier
  ds_read_b128 v[96:99], v16 offset:0
  ds_read_b128 v[100:103], v16 offset:2048
  ds_read_b64_tr_b16 v[88:89], v14 offset:0
  ds_read_b64_tr_b16 v[90:91], v14 offset:1024
  ds_read_b64_tr_b16 v[92:93], v15 offset:0
  ds_read_b64_tr_b16 v[94:95], v15 offset:1024
  s_waitcnt lgkmcnt(0)
  v_mfma_f32_32x32x16_bf16 v[24:39], v[88:91], v[96:99], 0
  ds_read_b128 v[112:115], v17 offset:0
  ds_read_b128 v[116:119], v17 offset:2048
  v_mfma_f32_32x32x16_bf16 v[40:55], v[88:91], v[100:103], 0
  ds_read_b64_tr_b16 v[104:105], v14 offset:4096
  ds_read_b64_tr_b16 v[106:107], v14 offset:5120
  v_mfma_f32_32x32x16_bf16 v[56:71], v[92:95], v[96:99], 0
  ds_read_b64_tr_b16 v[108:109], v15 offset:4096
  ds_read_b64_tr_b16 v[110:111], v15 offset:5120
  v_mfma_f32_32x32x16_bf16 v[72:87], v[92:95], v[100:103], 0
  s_cmp_le_u32 s51, 4
  s_cselect_b32 s38, s49, s40
  s_cselect_b32 s39, s50, s41
  s_add_u32 s38, s38, 442368
  s_add_u32 s39, s39, 256
  s_add_u32 m0, s42, 65536
  s_nop 0
  buffer_load_dwordx4 v10, s[12:15], s38 offen lds
  buffer_load_dwordx4 v11, s[12:15], s38 offen offset:1024 lds
  s_add_u32 m0, s43, 65536
  s_nop 0
  buffer_load_dwordx4 v12, s[8:11], s39 offen lds
  buffer_load_dwordx4 v13, s[8:11], s39 offen offset:1024 lds
  v_mfma_f32_32x32x16_bf16 v[148:163], v[88:91], v[164:167], 0
  s_waitcnt lgkmcnt(0)
  s_waitcnt vmcnt(12)
  s_barrier
  v_mfma_f32_32x32x16_bf16 v[24:39], v[104:107], v[112:115], v[24:39]
  ds_read_b128 v[96:99], v16 offset:16384
  ds_read_b128 v[100:103], v16 offset:18432
  v_mfma_f32_32x32x16_bf16 v[40:55], v[104:107], v[116:119], v[40:55]
  ds_read_b64_tr_b16 v[88:89], v14 offset:16384
  ds_read_b64_tr_b16 v[90:91], v14 offset:17408
  v_mfma_f32_32x32x16_bf16 v[56:71], v[108:111], v[112:115], v[56:71]
  ds_read_b64_tr_b16 v[92:93], v15 offset:16384
  ds_read_b64_tr_b16 v[94:95], v15 offset:17408
  s_cmp_le_u32 s51, 5
  s_cselect_b32 s38, s49, s40
  s_cselect_b32 s39, s50, s41
  s_add_u32 s38, s38, 552960
  v_mfma_f32_32x32x16_bf16 v[72:87], v[108:111], v[116:119], v[72:87]
  s_add_u32 s39, s39, 320
  s_add_u32 m0, s42, 0
  s_nop 0
  buffer_load_dwordx4 v10, s[12:15], s38 offen lds
  buffer_load_dwordx4 v11, s[12:15], s38 offen offset:1024 lds
  v_mfma_f32_32x32x16_bf16 v[148:163], v[104:107], v[164:167], v[148:163]
  s_waitcnt lgkmcnt(0)
  v_mfma_f32_32x32x16_bf16 v[24:39], v[88:91], v[96:99], v[24:39]
  ds_read_b128 v[112:115], v17 offset:16384
  ds_read_b128 v[116:119], v17 offset:18432
  v_mfma_f32_32x32x16_bf16 v[40:55], v[88:91], v[100:103], v[40:55]
  ds_read_b64_tr_b16 v[104:105], v14 offset:20480
  ds_read_b64_tr_b16 v[106:107], v14 offset:21504
  v_mfma_f32_32x32x16_bf16 v[56:71], v[92:95], v[96:99], v[56:71]
  ds_read_b64_tr_b16 v[108:109], v15 offset:20480
  ds_read_b64_tr_b16 v[110:111], v15 offset:21504
  v_mfma_f32_32x32x16_bf16 v[72:87], v[92:95], v[100:103], v[72:87]
  s_add_u32 m0, s43, 0
  s_nop 0
  buffer_load_dwordx4 v12, s[8:11], s39 offen lds
  buffer_load_dwordx4 v13, s[8:11], s39 offen offset:1024 lds
  v_mfma_f32_32x32x16_bf16 v[148:163], v[88:91], v[164:167], v[148:163]
  s_waitcnt lgkmcnt(0)
  s_waitcnt vmcnt(12)
  s_barrier
  v_mfma_f32_32x32x16_bf16 v[24:39], v[104:107], v[112:115], v[24:39]
  ds_read_b128 v[96:99], v16 offset:32768
  ds_read_b128 v[100:103], v16 offset:34816
  v_mfma_f32_32x32x16_bf16 v[40:55], v[104:107], v[116:119], v[40:55]
  ds_read_b64_tr_b16 v[88:89], v14 offset:32768
  ds_read_b64_tr_b16 v[90:91], v14 offset:33792
  v_mfma_f32_32x32x16_bf16 v[56:71], v[108:111], v[112:115], v[56:71]
  ds_read_b64_tr_b16 v[92:93], v15 offset:32768
  ds_read_b64_tr_b16 v[94:95], v15 offset:33792
  s_cmp_le_u32 s51, 6
  s_cselect_b32 s38, s49, s40
  s_cselect_b32 s39, s50, s41
  s_add_u32 s38, s38, 663552
  v_mfma_f32_32x32x16_bf16 v[72:87], v[108:111], v[116:119], v[72:87]
  s_add_u32 s39, s39, 384
  s_add_u32 m0, s42, 16384
  s_nop 0
  buffer_load_dwordx4 v10, s[12:15], s38 offen lds
  buffer_load_dwordx4 v11, s[12:15], s38 offen offset:1024 lds
  v_mfma_f32_32x32x16_bf16 v[148:163], v[104:107], v[164:167], v[148:163]
  s_waitcnt lgkmcnt(0)
  v_mfma_f32_32x32x16_bf16 v[24:39], v[88:91], v[96:99], v[24:39]
  ds_read_b128 v[112:115], v17 offset:32768
  ds_read_b128 v[116:119], v17 offset:34816
  v_mfma_f32_32x32x16_bf16 v[40:55], v[88:91], v[100:103], v[40:55]
  ds_read_b64_tr_b16 v[104:105], v14 offset:36864
  ds_read_b64_tr_b16 v[106:107], v14 offset:37888
  v_mfma_f32_32x32x16_bf16 v[56:71], v[92:95], v[96:99], v[56:71]
  ds_read_b64_tr_b16 v[108:109], v15 offset:36864
  ds_read_b64_tr_b16 v[110:111], v15 offset:37888
  v_mfma_f32_32x32x16_bf16 v[72:87], v[92:95], v[100:103], v[72:87]
  s_add_u32 m0, s43, 16384
  s_nop 0
  buffer_load_dwordx4 v12, s[8:11], s39 offen lds
  buffer_load_dwordx4 v13, s[8:11], s39 offen offset:1024 lds
  v_mfma_f32_32x32x16_bf16 v[148:163], v[88:91], v[164:167], v[148:163]
  s_waitcnt lgkmcnt(0)
  s_waitcnt vmcnt(12)
  s_barrier
  v_mfma_f32_32x32x16_bf16 v[24:39], v[104:107], v[112:115], v[24:39]
  ds_read_b128 v[96:99], v20 offset:0
  ds_read_b128 v[100:103], v20 offset:2048
  v_mfma_f32_32x32x16_bf16 v[40:55], v[104:107], v[116:119], v[40:55]
  ds_read_b64_tr_b16 v[88:89], v18 offset:0
  ds_read_b64_tr_b16 v[90:91], v18 offset:1024
  v_mfma_f32_32x32x16_bf16 v[56:71], v[108:111], v[112:115], v[56:71]
  ds_read_b64_tr_b16 v[92:93], v19 offset:0
  ds_read_b64_tr_b16 v[94:95], v19 offset:1024
  s_cmp_le_u32 s51, 7
  s_cselect_b32 s38, s49, s40
  s_cselect_b32 s39, s50, s41
  s_add_u32 s38, s38, 774144
  v_mfma_f32_32x32x16_bf16 v[72:87], v[108:111], v[116:119], v[72:87]
  s_add_u32 s39, s39, 448
  s_add_u32 m0, s42, 32768
  s_nop 0
  buffer_load_dwordx4 v10, s[12:15], s38 offen lds
  buffer_load_dwordx4 v11, s[12:15], s38 offen offset:1024 lds
  v_mfma_f32_32x32x16_bf16 v[148:163], v[104:107], v[164:167], v[148:163]
  s_waitcnt lgkmcnt(0)
  v_mfma_f32_32x32x16_bf16 v[24:39], v[88:91], v[96:99], v[24:39]
  ds_read_b128 v[112:115], v21 offset:0
  ds_read_b128 v[116:119], v21 offset:2048
  v_mfma_f32_32x32x16_bf16 v[40:55], v[88:91], v[100:103], v[40:55]
  ds_read_b64_tr_b16 v[104:105], v18 offset:4096
  ds_read_b64_tr_b16 v[106:107], v18 offset:5120
  v_mfma_f32_32x32x16_bf16 v[56:71], v[92:95], v[96:99], v[56:71]
  ds_read_b64_tr_b16 v[108:109], v19 offset:4096
  ds_read_b64_tr_b16 v[110:111], v19 offset:5120
  v_mfma_f32_32x32x16_bf16 v[72:87], v[92:95], v[100:103], v[72:87]
  s_add_u32 m0, s43, 32768
  s_nop 0
  buffer_load_dwordx4 v12, s[8:11], s39 offen lds
  buffer_load_dwordx4 v13, s[8:11], s39 offen offset:1024 lds
  v_mfma_f32_32x32x16_bf16 v[148:163], v[88:91], v[164:167], v[148:163]
  s_waitcnt lgkmcnt(0)
  s_waitcnt vmcnt(12)
  s_barrier
  v_mfma_f32_32x32x16_bf16 v[24:39], v[104:107], v[112:115], v[24:39]
  ds_read_b128 v[96:99], v20 offset:16384
  ds_read_b128 v[100:103], v20 offset:18432
  v_mfma_f32_32x32x16_bf16 v[40:55], v[104:107], v[116:119], v[40:55]
  ds_read_b64_tr_b16 v[88:89], v18 offset:16384
  ds_read_b64_tr_b16 v[90:91], v18 offset:17408
  v_mfma_f32_32x32x16_bf16 v[56:71], v[108:111], v[112:115], v[56:71]
  ds_read_b64_tr_b16 v[92:93], v19 offset:16384
  ds_read_b64_tr_b16 v[94:95], v19 offset:17408
  s_cmp_le_u32 s51, 8
  s_cselect_b32 s38, s49, s40
  s_cselect_b32 s39, s50, s41
  s_add_u32 s38, s38, 884736
  v_mfma_f32_32x32x16_bf16 v[72:87], v[108:111], v[116:119], v[72:87]
  s_add_u32 s39, s39, 512
  s_add_u32 m0, s42, 49152
  s_nop 0
  buffer_load_dwordx4 v10, s[12:15], s38 offen lds
  buffer_load_dwordx4 v11, s[12:15], s38 offen offset:1024 lds
  v_mfma_f32_32x32x16_bf16 v[148:163], v[104:107], v[164:167], v[148:163]
  s_waitcnt lgkmcnt(0)
  v_mfma_f32_32x32x16_bf16 v[24:39], v[88:91], v[96:99], v[24:39]
  ds_read_b128 v[112:115], v21 offset:16384
  ds_read_b128 v[116:119], v21 offset:18432
  v_mfma_f32_32x32x16_bf16 v[40:55], v[88:91], v[100:103], v[40:55]
  ds_read_b64_tr_b16 v[104:105], v18 offset:20480
  ds_read_b64_tr_b16 v[106:107], v18 offset:21504
  v_mfma_f32_32x32x16_bf16 v[56:71], v[92:95], v[96:99], v[56:71]
  ds_read_b64_tr_b16 v[108:109], v19 offset:20480
  ds_read_b64_tr_b16 v[110:111], v19 offset:21504
  v_mfma_f32_32x32x16_bf16 v[72:87], v[92:95], v[100:103], v[72:87]
  s_add_u32 m0, s43, 49152
  s_nop 0
  buffer_load_dwordx4 v12, s[8:11], s39 offen lds
  buffer_load_dwordx4 v13, s[8:11], s39 offen offset:1024 lds
  v_mfma_f32_32x32x16_bf16 v[148:163], v[88:91], v[164:167], v[148:163]
  s_waitcnt lgkmcnt(0)
  s_waitcnt vmcnt(12)
  s_barrier
  v_mfma_f32_32x32x16_bf16 v[24:39], v[104:107], v[112:115], v[24:39]
  ds_read_b128 v[96:99], v16 offset:0
  ds_read_b128 v[100:103], v16 offset:2048
  v_mfma_f32_32x32x16_bf16 v[40:55], v[104:107], v[116:119], v[40:55]
  ds_read_b64_tr_b16 v[88:89], v14 offset:0
  ds_read_b64_tr_b16 v[90:91], v14 offset:1024
  v_mfma_f32_32x32x16_bf16 v[56:71], v[108:111], v[112:115], v[56:71]
  ds_read_b64_tr_b16 v[92:93], v15 offset:0
  ds_read_b64_tr_b16 v[94:95], v15 offset:1024
  s_cmp_le_u32 s51, 9
  s_cselect_b32 s38, s49, s40
  s_cselect_b32 s39, s50, s41
  s_add_u32 s38, s38, 995328
  v_mfma_f32_32x32x16_bf16 v[72:87], v[108:111], v[116:119], v[72:87]
  s_add_u32 s39, s39, 576
  s_add_u32 m0, s42, 65536
  s_nop 0
  buffer_load_dwordx4 v10, s[12:15], s38 offen lds
  buffer_load_dwordx4 v11, s[12:15], s38 offen offset:1024 lds
  v_mfma_f32_32x32x16_bf16 v[148:163], v[104:107], v[164:167], v[148:163]
  s_waitcnt lgkmcnt(0)
  v_mfma_f32_32x32x16_bf16 v[24:39], v[88:91], v[96:99], v[24:39]
  ds_read_b128 v[112:115], v17 offset:0
  ds_read_b128 v[116:119], v17 offset:2048
  v_mfma_f32_32x32x16_bf16 v[40:55], v[88:91], v[100:103], v[40:55]
  ds_read_b64_tr_b16 v[104:105], v14 offset:4096
  ds_read_b64_tr_b16 v[106:107], v14 offset:5120
  v_mfma_f32_32x32x16_bf16 v[56:71], v[92:95], v[96:99], v[56:71]
  ds_read_b64_tr_b16 v[108:109], v15 offset:4096
  ds_read_b64_tr_b16 v[110:111], v15 offset:5120
  v_mfma_f32_32x32x16_bf16 v[72:87], v[92:95], v[100:103], v[72:87]
  s_add_u32 m0, s43, 65536
  s_nop 0
  buffer_load_dwordx4 v12, s[8:11], s39 offen lds
  buffer_load_dwordx4 v13, s[8:11], s39 offen offset:1024 lds
  v_mfma_f32_32x32x16_bf16 v[148:163], v[88:91], v[164:167], v[148:163]
  s_waitcnt lgkmcnt(0)
  s_waitcnt vmcnt(12)
  s_barrier
  v_mfma_f32_32x32x16_bf16 v[24:39], v[104:107], v[112:115], v[24:39]
  ds_read_b128 v[96:99], v16 offset:16384
  ds_read_b128 v[100:103], v16 offset:18432
  v_mfma_f32_32x32x16_bf16 v[40:55], v[104:107], v[116:119], v[40:55]
  ds_read_b64_tr_b16 v[88:89], v14 offset:16384
  ds_read_b64_tr_b16 v[90:91], v14 offset:17408
  v_mfma_f32_32x32x16_bf16 v[56:71], v[108:111], v[112:115], v[56:71]
  ds_read_b64_tr_b16 v[92:93], v15 offset:16384
  ds_read_b64_tr_b16 v[94:95], v15 offset:17408
  s_cmp_le_u32 s51, 10
  s_cselect_b32 s38, s49, s40
  s_cselect_b32 s39, s50, s41
  s_add_u32 s38, s38, 1105920
  v_mfma_f32_32x32x16_bf16 v[72:87], v[108:111], v[116:119], v[72:87]
  s_add_u32 s39, s39, 640
  s_add_u32 m0, s42, 0
  s_nop 0
  buffer_load_dwordx4 v10, s[12:15], s38 offen lds
  buffer_load_dwordx4 v11, s[12:15], s38 offen offset:1024 lds
  v_mfma_f32_32x32x16_bf16 v[148:163], v[104:107], v[164:167], v[148:163]
  s_waitcnt lgkmcnt(0)
  v_mfma_f32_32x32x16_bf16 v[24:39], v[88:91], v[96:99], v[24:39]
  ds_read_b128 v[112:115], v17 offset:16384
  ds_read_b128 v[116:119], v17 offset:18432
  v_mfma_f32_32x32x16_bf16 v[40:55], v[88:91], v[100:103], v[40:55]
  ds_read_b64_tr_b16 v[104:105], v14 offset:20480
  ds_read_b64_tr_b16 v[106:107], v14 offset:21504
  v_mfma_f32_32x32x16_bf16 v[56:71], v[92:95], v[96:99], v[56:71]
  ds_read_b64_tr_b16 v[108:109], v15 offset:20480
  ds_read_b64_tr_b16 v[110:111], v15 offset:21504
  v_mfma_f32_32x32x16_bf16 v[72:87], v[92:95], v[100:103], v[72:87]
  s_add_u32 m0, s43, 0
  s_nop 0
  buffer_load_dwordx4 v12, s[8:11], s39 offen lds
  buffer_load_dwordx4 v13, s[8:11], s39 offen offset:1024 lds
  v_mfma_f32_32x32x16_bf16 v[148:163], v[88:91], v[164:167], v[148:163]
  s_waitcnt lgkmcnt(0)
  s_waitcnt vmcnt(12)
  s_barrier
  v_mfma_f32_32x32x16_bf16 v[24:39], v[104:107], v[112:115], v[24:39]
  ds_read_b128 v[96:99], v16 offset:32768
  ds_read_b128 v[100:103], v16 offset:34816
  v_mfma_f32_32x32x16_bf16 v[40:55], v[104:107], v[116:119], v[40:55]
  ds_read_b64_tr_b16 v[88:89], v14 offset:32768
  ds_read_b64_tr_b16 v[90:91], v14 offset:33792
  v_mfma_f32_32x32x16_bf16 v[56:71], v[108:111], v[112:115], v[56:71]
  ds_read_b64_tr_b16 v[92:93], v15 offset:32768
  ds_read_b64_tr_b16 v[94:95], v15 offset:33792
  s_cmp_le_u32 s51, 11
  s_cselect_b32 s38, s49, s40
  s_cselect_b32 s39, s50, s41
  s_add_u32 s38, s38, 1216512
  v_mfma_f32_32x32x16_bf16 v[72:87], v[108:111], v[116:119], v[72:87]
  s_add_u32 s39, s39, 704
  s_add_u32 m0, s42, 16384
  s_nop 0
  buffer_load_dwordx4 v10, s[12:15], s38 offen lds
  buffer_load_dwordx4 v11, s[12:15], s38 offen offset:1024 lds
  v_mfma_f32_32x32x16_bf16 v[148:163], v[104:107], v[164:167], v[148:163]
  s_waitcnt lgkmcnt(0)
  v_mfma_f32_32x32x16_bf16 v[24:39], v[88:91], v[96:99], v[24:39]
  ds_read_b128 v[112:115], v17 offset:32768
  ds_read_b128 v[116:119], v17 offset:34816
  v_mfma_f32_32x32x16_bf16 v[40:55], v[88:91], v[100:103], v[40:55]
  ds_read_b64_tr_b16 v[104:105], v14 offset:36864
  ds_read_b64_tr_b16 v[106:107], v14 offset:37888
  v_mfma_f32_32x32x16_bf16 v[56:71], v[92:95], v[96:99], v[56:71]
  ds_read_b64_tr_b16 v[108:109], v15 offset:36864
  ds_read_b64_tr_b16 v[110:111], v15 offset:37888
  v_mfma_f32_32x32x16_bf16 v[72:87], v[92:95], v[100:103], v[72:87]
  s_add_u32 m0, s43, 16384
  s_nop 0
  buffer_load_dwordx4 v12, s[8:11], s39 offen lds
  buffer_load_dwordx4 v13, s[8:11], s39 offen offset:1024 lds
  v_mfma_f32_32x32x16_bf16 v[148:163], v[88:91], v[164:167], v[148:163]
  s_waitcnt lgkmcnt(0)
  s_waitcnt vmcnt(12)
  s_barrier
  v_mfma_f32_32x32x16_bf16 v[24:39], v[104:107], v[112:115], v[24:39]
  ds_read_b128 v[96:99], v20 offset:0
  ds_read_b128 v[100:103], v20 offset:2048
  v_mfma_f32_32x32x16_bf16 v[40:55], v[104:107], v[116:119], v[40:55]
  ds_read_b64_tr_b16 v[88:89], v18 offset:0
  ds_read_b64_tr_b16 v[90:91], v18 offset:1024
  v_mfma_f32_32x32x16_bf16 v[56:71], v[108:111], v[112:115], v[56:71]
  ds_read_b64_tr_b16 v[92:93], v19 offset:0
  ds_read_b64_tr_b16 v[94:95], v19 offset:1024
  s_cmp_le_u32 s51, 12
  s_cselect_b32 s38, s49, s40
  s_cselect_b32 s39, s50, s41
  s_add_u32 s38, s38, 1327104
  v_mfma_f32_32x32x16_bf16 v[72:87], v[108:111], v[116:119], v[72:87]
  s_add_u32 s39, s39, 768
  s_add_u32 m0, s42, 32768
  s_nop 0
  buffer_load_dwordx4 v10, s[12:15], s38 offen lds
  buffer_load_dwordx4 v11, s[12:15], s38 offen offset:1024 lds
  v_mfma_f32_32x32x16_bf16 v[148:163], v[104:107], v[164:167], v[148:163]
  s_waitcnt lgkmcnt(0)
  v_mfma_f32_32x32x16_bf16 v[24:39], v[88:91], v[96:99], v[24:39]
  ds_read_b128 v[112:115], v21 offset:0
  ds_read_b128 v[116:119], v21 offset:2048
  v_mfma_f32_32x32x16_bf16 v[40:55], v[88:91], v[100:103], v[40:55]
  ds_read_b64_tr_b16 v[104:105], v18 offset:4096
  ds_read_b64_tr_b16 v[106:107], v18 offset:5120
  v_mfma_f32_32x32x16_bf16 v[56:71], v[92:95], v[96:99], v[56:71]
  ds_read_b64_tr_b16 v[108:109], v19 offset:4096
  ds_read_b64_tr_b16 v[110:111], v19 offset:5120
  v_mfma_f32_32x32x16_bf16 v[72:87], v[92:95], v[100:103], v[72:87]
  s_add_u32 m0, s43, 32768
  s_nop 0
  buffer_load_dwordx4 v12, s[8:11], s39 offen lds
  buffer_load_dwordx4 v13, s[8:11], s39 offen offset:1024 lds
  v_mfma_f32_32x32x16_bf16 v[148:163], v[88:91], v[164:167], v[148:163]
  s_waitcnt lgkmcnt(0)
  s_waitcnt vmcnt(12)
  s_barrier
  v_mfma_f32_32x32x16_bf16 v[24:39], v[104:107], v[112:115], v[24:39]
  ds_read_b128 v[96:99], v20 offset:16384
  ds_read_b128 v[100:103], v20 offset:18432
  v_mfma_f32_32x32x16_bf16 v[40:55], v[104:107], v[116:119], v[40:55]
  ds_read_b64_tr_b16 v[88:89], v18 offset:16384
  ds_read_b64_tr_b16 v[90:91], v18 offset:17408
  v_mfma_f32_32x32x16_bf16 v[56:71], v[108:111], v[112:115], v[56:71]
  ds_read_b64_tr_b16 v[92:93], v19 offset:16384
  ds_read_b64_tr_b16 v[94:95], v19 offset:17408
  s_cmp_le_u32 s51, 13
  s_cselect_b32 s38, s49, s40
  s_cselect_b32 s39, s50, s41
  s_add_u32 s38, s38, 1437696
  v_mfma_f32_32x32x16_bf16 v[72:87], v[108:111], v[116:119], v[72:87]
  s_add_u32 s39, s39, 832
  s_add_u32 m0, s42, 49152
  s_nop 0
  buffer_load_dwordx4 v10, s[12:15], s38 offen lds
  buffer_load_dwordx4 v11, s[12:15], s38 offen offset:1024 lds
  v_mfma_f32_32x32x16_bf16 v[148:163], v[104:107], v[164:167], v[148:163]
  s_waitcnt lgkmcnt(0)
  v_mfma_f32_32x32x16_bf16 v[24:39], v[88:91], v[96:99], v[24:39]
  ds_read_b128 v[112:115], v21 offset:16384
  ds_read_b128 v[116:119], v21 offset:18432
  v_mfma_f32_32x32x16_bf16 v[40:55], v[88:91], v[100:103], v[40:55]
  ds_read_b64_tr_b16 v[104:105], v18 offset:20480
  ds_read_b64_tr_b16 v[106:107], v18 offset:21504
  v_mfma_f32_32x32x16_bf16 v[56:71], v[92:95], v[96:99], v[56:71]
  ds_read_b64_tr_b16 v[108:109], v19 offset:20480
  ds_read_b64_tr_b16 v[110:111], v19 offset:21504
  v_mfma_f32_32x32x16_bf16 v[72:87], v[92:95], v[100:103], v[72:87]
  s_add_u32 m0, s43, 49152
  s_nop 0
  buffer_load_dwordx4 v12, s[8:11], s39 offen lds
  buffer_load_dwordx4 v13, s[8:11], s39 offen offset:1024 lds
  v_mfma_f32_32x32x16_bf16 v[148:163], v[88:91], v[164:167], v[148:163]
  s_waitcnt lgkmcnt(0)
  s_waitcnt vmcnt(12)
  s_barrier
  v_mfma_f32_32x32x16_bf16 v[24:39], v[104:107], v[112:115], v[24:39]
  ds_read_b128 v[96:99], v16 offset:0
  ds_read_b128 v[100:103], v16 offset:2048
  v_mfma_f32_32x32x16_bf16 v[40:55], v[104:107], v[116:119], v[40:55]
  ds_read_b64_tr_b16 v[88:89], v14 offset:0
  ds_read_b64_tr_b16 v[90:91], v14 offset:1024
  v_mfma_f32_32x32x16_bf16 v[56:71], v[108:111], v[112:115], v[56:71]
  ds_read_b64_tr_b16 v[92:93], v15 offset:0
  ds_read_b64_tr_b16 v[94:95], v15 offset:1024
  s_cmp_le_u32 s51, 14
  s_cselect_b32 s38, s49, s40
  s_cselect_b32 s39, s50, s41
  s_add_u32 s38, s38, 1548288
  v_mfma_f32_32x32x16_bf16 v[72:87], v[108:111], v[116:119], v[72:87]
  s_add_u32 s39, s39, 896
  s_add_u32 m0, s42, 65536
  s_nop 0
  buffer_load_dwordx4 v10, s[12:15], s38 offen lds
  buffer_load_dwordx4 v11, s[12:15], s38 offen offset:1024 lds
  v_mfma_f32_32x32x16_bf16 v[148:163], v[104:107], v[164:167], v[148:163]
  s_waitcnt lgkmcnt(0)
  v_mfma_f32_32x32x16_bf16 v[24:39], v[88:91], v[96:99], v[24:39]
  ds_read_b128 v[112:115], v17 offset:0
  ds_read_b128 v[116:119], v17 offset:2048
  v_mfma_f32_32x32x16_bf16 v[40:55], v[88:91], v[100:103], v[40:55]
  ds_read_b64_tr_b16 v[104:105], v14 offset:4096
  ds_read_b64_tr_b16 v[106:107], v14 offset:5120
  v_mfma_f32_32x32x16_bf16 v[56:71], v[92:95], v[96:99], v[56:71]
  ds_read_b64_tr_b16 v[108:109], v15 offset:4096
  ds_read_b64_tr_b16 v[110:111], v15 offset:5120
  v_mfma_f32_32x32x16_bf16 v[72:87], v[92:95], v[100:103], v[72:87]
  s_add_u32 m0, s43, 65536
  s_nop 0
  buffer_load_dwordx4 v12, s[8:11], s39 offen lds
  buffer_load_dwordx4 v13, s[8:11], s39 offen offset:1024 lds
  v_mfma_f32_32x32x16_bf16 v[148:163], v[88:91], v[164:167], v[148:163]
  s_waitcnt lgkmcnt(0)
  s_waitcnt vmcnt(12)
  s_barrier
  v_mfma_f32_32x32x16_bf16 v[24:39], v[104:107], v[112:115], v[24:39]
  ds_read_b128 v[96:99], v16 offset:16384
  ds_read_b128 v[100:103], v16 offset:18432
  v_mfma_f32_32x32x16_bf16 v[40:55], v[104:107], v[116:119], v[40:55]
  ds_read_b64_tr_b16 v[88:89], v14 offset:16384
  ds_read_b64_tr_b16 v[90:91], v14 offset:17408
  v_mfma_f32_32x32x16_bf16 v[56:71], v[108:111], v[112:115], v[56:71]
  ds_read_b64_tr_b16 v[92:93], v15 offset:16384
  ds_read_b64_tr_b16 v[94:95], v15 offset:17408
  s_cmp_le_u32 s51, 15
  s_cselect_b32 s38, s49, s40
  s_cselect_b32 s39, s50, s41
  s_add_u32 s38, s38, 1658880
  v_mfma_f32_32x32x16_bf16 v[72:87], v[108:111], v[116:119], v[72:87]
  s_add_u32 s39, s39, 960
  s_add_u32 m0, s42, 0
  s_nop 0
  buffer_load_dwordx4 v10, s[12:15], s38 offen lds
  buffer_load_dwordx4 v11, s[12:15], s38 offen offset:1024 lds
  v_mfma_f32_32x32x16_bf16 v[148:163], v[104:107], v[164:167], v[148:163]
  s_waitcnt lgkmcnt(0)
  v_mfma_f32_32x32x16_bf16 v[24:39], v[88:91], v[96:99], v[24:39]
  ds_read_b128 v[112:115], v17 offset:16384
  ds_read_b128 v[116:119], v17 offset:18432
  v_mfma_f32_32x32x16_bf16 v[40:55], v[88:91], v[100:103], v[40:55]
  ds_read_b64_tr_b16 v[104:105], v14 offset:20480
  ds_read_b64_tr_b16 v[106:107], v14 offset:21504
  v_mfma_f32_32x32x16_bf16 v[56:71], v[92:95], v[96:99], v[56:71]
  ds_read_b64_tr_b16 v[108:109], v15 offset:20480
  ds_read_b64_tr_b16 v[110:111], v15 offset:21504
  v_mfma_f32_32x32x16_bf16 v[72:87], v[92:95], v[100:103], v[72:87]
  s_add_u32 m0, s43, 0
  s_nop 0
  buffer_load_dwordx4 v12, s[8:11], s39 offen lds
  buffer_load_dwordx4 v13, s[8:11], s39 offen offset:1024 lds
  v_mfma_f32_32x32x16_bf16 v[148:163], v[88:91], v[164:167], v[148:163]
  s_waitcnt lgkmcnt(0)
  s_waitcnt vmcnt(12)
  s_barrier
  v_mfma_f32_32x32x16_bf16 v[24:39], v[104:107], v[112:115], v[24:39]
  ds_read_b128 v[96:99], v16 offset:32768
  ds_read_b128 v[100:103], v16 offset:34816
  v_mfma_f32_32x32x16_bf16 v[40:55], v[104:107], v[116:119], v[40:55]
  ds_read_b64_tr_b16 v[88:89], v14 offset:32768
  ds_read_b64_tr_b16 v[90:91], v14 offset:33792
  v_mfma_f32_32x32x16_bf16 v[56:71], v[108:111], v[112:115], v[56:71]
  ds_read_b64_tr_b16 v[92:93], v15 offset:32768
  ds_read_b64_tr_b16 v[94:95], v15 offset:33792
  s_cmp_le_u32 s51, 16
  s_cselect_b32 s38, s49, s40
  s_cselect_b32 s39, s50, s41
  s_add_u32 s38, s38, 1769472
  v_mfma_f32_32x32x16_bf16 v[72:87], v[108:111], v[116:119], v[72:87]
  s_add_u32 s39, s39, 1024
  s_add_u32 m0, s42, 16384
  s_nop 0
  buffer_load_dwordx4 v10, s[12:15], s38 offen lds
  buffer_load_dwordx4 v11, s[12:15], s38 offen offset:1024 lds
  v_mfma_f32_32x32x16_bf16 v[148:163], v[104:107], v[164:167], v[148:163]
  s_waitcnt lgkmcnt(0)
  v_mfma_f32_32x32x16_bf16 v[24:39], v[88:91], v[96:99], v[24:39]
  ds_read_b128 v[112:115], v17 offset:32768
  ds_read_b128 v[116:119], v17 offset:34816
  v_mfma_f32_32x32x16_bf16 v[40:55], v[88:91], v[100:103], v[40:55]
  ds_read_b64_tr_b16 v[104:105], v14 offset:36864
  ds_read_b64_tr_b16 v[106:107], v14 offset:37888
  v_mfma_f32_32x32x16_bf16 v[56:71], v[92:95], v[96:99], v[56:71]
  ds_read_b64_tr_b16 v[108:109], v15 offset:36864
  ds_read_b64_tr_b16 v[110:111], v15 offset:37888
  v_mfma_f32_32x32x16_bf16 v[72:87], v[92:95], v[100:103], v[72:87]
  s_add_u32 m0, s43, 16384
  s_nop 0
  buffer_load_dwordx4 v12, s[8:11], s39 offen lds
  buffer_load_dwordx4 v13, s[8:11], s39 offen offset:1024 lds
  v_mfma_f32_32x32x16_bf16 v[148:163], v[88:91], v[164:167], v[148:163]
  s_waitcnt lgkmcnt(0)
  s_waitcnt vmcnt(12)
  s_barrier
  v_mfma_f32_32x32x16_bf16 v[24:39], v[104:107], v[112:115], v[24:39]
  ds_read_b128 v[96:99], v20 offset:0
  ds_read_b128 v[100:103], v20 offset:2048
  v_mfma_f32_32x32x16_bf16 v[40:55], v[104:107], v[116:119], v[40:55]
  ds_read_b64_tr_b16 v[88:89], v18 offset:0
  ds_read_b64_tr_b16 v[90:91], v18 offset:1024
  v_mfma_f32_32x32x16_bf16 v[56:71], v[108:111], v[112:115], v[56:71]
  ds_read_b64_tr_b16 v[92:93], v19 offset:0
  ds_read_b64_tr_b16 v[94:95], v19 offset:1024
  s_cmp_le_u32 s51, 17
  s_cselect_b32 s38, s49, s40
  s_cselect_b32 s39, s50, s41
  s_add_u32 s38, s38, 1880064
  v_mfma_f32_32x32x16_bf16 v[72:87], v[108:111], v[116:119], v[72:87]
  s_add_u32 s39, s39, 1088
  s_add_u32 m0, s42, 32768
  s_nop 0
  buffer_load_dwordx4 v10, s[12:15], s38 offen lds
  buffer_load_dwordx4 v11, s[12:15], s38 offen offset:1024 lds
  v_mfma_f32_32x32x16_bf16 v[148:163], v[104:107], v[164:167], v[148:163]
  s_waitcnt lgkmcnt(0)
  v_mfma_f32_32x32x16_bf16 v[24:39], v[88:91], v[96:99], v[24:39]
  ds_read_b128 v[112:115], v21 offset:0
  ds_read_b128 v[116:119], v21 offset:2048
  v_mfma_f32_32x32x16_bf16 v[40:55], v[88:91], v[100:103], v[40:55]
  ds_read_b64_tr_b16 v[104:105], v18 offset:4096
  ds_read_b64_tr_b16 v[106:107], v18 offset:5120
  v_mfma_f32_32x32x16_bf16 v[56:71], v[92:95], v[96:99], v[56:71]
  ds_read_b64_tr_b16 v[108:109], v19 offset:4096
  ds_read_b64_tr_b16 v[110:111], v19 offset:5120
  v_mfma_f32_32x32x16_bf16 v[72:87], v[92:95], v[100:103], v[72:87]
  s_add_u32 m0, s43, 32768
  s_nop 0
  buffer_load_dwordx4 v12, s[8:11], s39 offen lds
  buffer_load_dwordx4 v13, s[8:11], s39 offen offset:1024 lds
  v_mfma_f32_32x32x16_bf16 v[148:163], v[88:91], v[164:167], v[148:163]
  s_waitcnt lgkmcnt(0)
  s_waitcnt vmcnt(12)
  s_barrier
  v_mfma_f32_32x32x16_bf16 v[24:39], v[104:107], v[112:115], v[24:39]
  ds_read_b128 v[96:99], v20 offset:16384
  ds_read_b128 v[100:103], v20 offset:18432
  v_mfma_f32_32x32x16_bf16 v[40:55], v[104:107], v[116:119], v[40:55]
  ds_read_b64_tr_b16 v[88:89], v18 offset:16384
  ds_read_b64_tr_b16 v[90:91], v18 offset:17408
  v_mfma_f32_32x32x16_bf16 v[56:71], v[108:111], v[112:115], v[56:71]
  ds_read_b64_tr_b16 v[92:93], v19 offset:16384
  ds_read_b64_tr_b16 v[94:95], v19 offset:17408
  s_cmp_le_u32 s51, 18
  s_cselect_b32 s38, s49, s40
  s_cselect_b32 s39, s50, s41
  s_add_u32 s38, s38, 1990656
  v_mfma_f32_32x32x16_bf16 v[72:87], v[108:111], v[116:119], v[72:87]
  s_add_u32 s39, s39, 1152
  s_add_u32 m0, s42, 49152
  s_nop 0
  buffer_load_dwordx4 v10, s[12:15], s38 offen lds
  buffer_load_dwordx4 v11, s[12:15], s38 offen offset:1024 lds
  v_mfma_f32_32x32x16_bf16 v[148:163], v[104:107], v[164:167], v[148:163]
  s_waitcnt lgkmcnt(0)
  v_mfma_f32_32x32x16_bf16 v[24:39], v[88:91], v[96:99], v[24:39]
  ds_read_b128 v[112:115], v21 offset:16384
  ds_read_b128 v[116:119], v21 offset:18432
  v_mfma_f32_32x32x16_bf16 v[40:55], v[88:91], v[100:103], v[40:55]
  ds_read_b64_tr_b16 v[104:105], v18 offset:20480
  ds_read_b64_tr_b16 v[106:107], v18 offset:21504
  v_mfma_f32_32x32x16_bf16 v[56:71], v[92:95], v[96:99], v[56:71]
  ds_read_b64_tr_b16 v[108:109], v19 offset:20480
  ds_read_b64_tr_b16 v[110:111], v19 offset:21504
  v_mfma_f32_32x32x16_bf16 v[72:87], v[92:95], v[100:103], v[72:87]
  s_add_u32 m0, s43, 49152
  s_nop 0
  buffer_load_dwordx4 v12, s[8:11], s39 offen lds
  buffer_load_dwordx4 v13, s[8:11], s39 offen offset:1024 lds
  v_mfma_f32_32x32x16_bf16 v[148:163], v[88:91], v[164:167], v[148:163]
  s_waitcnt lgkmcnt(0)
  s_waitcnt vmcnt(12)
  s_barrier
  v_mfma_f32_32x32x16_bf16 v[24:39], v[104:107], v[112:115], v[24:39]
  ds_read_b128 v[96:99], v16 offset:0
  ds_read_b128 v[100:103], v16 offset:2048
  v_mfma_f32_32x32x16_bf16 v[40:55], v[104:107], v[116:119], v[40:55]
  ds_read_b64_tr_b16 v[88:89], v14 offset:0
  ds_read_b64_tr_b16 v[90:91], v14 offset:1024
  v_mfma_f32_32x32x16_bf16 v[56:71], v[108:111], v[112:115], v[56:71]
  ds_read_b64_tr_b16 v[92:93], v15 offset:0
  ds_read_b64_tr_b16 v[94:95], v15 offset:1024
  s_cmp_le_u32 s51, 19
  s_cselect_b32 s38, s49, s40
  s_cselect_b32 s39, s50, s41
  s_add_u32 s38, s38, 2101248
  v_mfma_f32_32x32x16_bf16 v[72:87], v[108:111], v[116:119], v[72:87]
  s_add_u32 s39, s39, 1216
  s_add_u32 m0, s42, 65536
  s_nop 0
  buffer_load_dwordx4 v10, s[12:15], s38 offen lds
  buffer_load_dwordx4 v11, s[12:15], s38 offen offset:1024 lds
  v_mfma_f32_32x32x16_bf16 v[148:163], v[104:107], v[164:167], v[148:163]
  s_waitcnt lgkmcnt(0)
  v_mfma_f32_32x32x16_bf16 v[24:39], v[88:91], v[96:99], v[24:39]
  ds_read_b128 v[112:115], v17 offset:0
  ds_read_b128 v[116:119], v17 offset:2048
  v_mfma_f32_32x32x16_bf16 v[40:55], v[88:91], v[100:103], v[40:55]
  ds_read_b64_tr_b16 v[104:105], v14 offset:4096
  ds_read_b64_tr_b16 v[106:107], v14 offset:5120
  v_mfma_f32_32x32x16_bf16 v[56:71], v[92:95], v[96:99], v[56:71]
  ds_read_b64_tr_b16 v[108:109], v15 offset:4096
  ds_read_b64_tr_b16 v[110:111], v15 offset:5120
  v_mfma_f32_32x32x16_bf16 v[72:87], v[92:95], v[100:103], v[72:87]
  s_add_u32 m0, s43, 65536
  s_nop 0
  buffer_load_dwordx4 v12, s[8:11], s39 offen lds
  buffer_load_dwordx4 v13, s[8:11], s39 offen offset:1024 lds
  s_lshl_b32 s46, s33, 7
  v_min_u32 v23, 15, v2
  v_lshlrev_b32 v23, 2, v23
  s_cmp_eq_u32 s32, 0
  s_cselect_b32 s46, s46, 0x7f000000
  v_add_u32 v23, s46, v23
  s_cselect_b32 s46, 0, 0x7f000000
  v_mov_b32 v3, s46
  buffer_load_dword v142, v3, s[28:31], 0 offen sc1
  buffer_load_dword v22, v23, s[4:7], 0 offen sc1
  v_mfma_f32_32x32x16_bf16 v[148:163], v[88:91], v[164:167], v[148:163]
  s_waitcnt lgkmcnt(0)
  s_waitcnt vmcnt(14)
  s_barrier
  v_mfma_f32_32x32x16_bf16 v[24:39], v[104:107], v[112:115], v[24:39]
  ds_read_b128 v[96:99], v16 offset:16384
  ds_read_b128 v[100:103], v16 offset:18432
  v_mfma_f32_32x32x16_bf16 v[40:55], v[104:107], v[116:119], v[40:55]
  ds_read_b64_tr_b16 v[88:89], v14 offset:16384
  ds_read_b64_tr_b16 v[90:91], v14 offset:17408
  v_mfma_f32_32x32x16_bf16 v[56:71], v[108:111], v[112:115], v[56:71]
  ds_read_b64_tr_b16 v[92:93], v15 offset:16384
  ds_read_b64_tr_b16 v[94:95], v15 offset:17408
  v_mfma_f32_32x32x16_bf16 v[72:87], v[108:111], v[116:119], v[72:87]
  v_mfma_f32_32x32x16_bf16 v[148:163], v[104:107], v[164:167], v[148:163]
  s_waitcnt lgkmcnt(0)
  v_mfma_f32_32x32x16_bf16 v[24:39], v[88:91], v[96:99], v[24:39]
  ds_read_b128 v[112:115], v17 offset:16384
  ds_read_b128 v[116:119], v17 offset:18432
  v_mfma_f32_32x32x16_bf16 v[40:55], v[88:91], v[100:103], v[40:55]
  ds_read_b64_tr_b16 v[104:105], v14 offset:20480
  ds_read_b64_tr_b16 v[106:107], v14 offset:21504
  v_mfma_f32_32x32x16_bf16 v[56:71], v[92:95], v[96:99], v[56:71]
  ds_read_b64_tr_b16 v[108:109], v15 offset:20480
  ds_read_b64_tr_b16 v[110:111], v15 offset:21504
  v_mfma_f32_32x32x16_bf16 v[72:87], v[92:95], v[100:103], v[72:87]
  v_mfma_f32_32x32x16_bf16 v[148:163], v[88:91], v[164:167], v[148:163]
  s_waitcnt lgkmcnt(0)
  s_waitcnt vmcnt(10)
  s_barrier
  v_mfma_f32_32x32x16_bf16 v[24:39], v[104:107], v[112:115], v[24:39]
  ds_read_b128 v[96:99], v16 offset:32768
  ds_read_b128 v[100:103], v16 offset:34816
  v_mfma_f32_32x32x16_bf16 v[40:55], v[104:107], v[116:119], v[40:55]
  ds_read_b64_tr_b16 v[88:89], v14 offset:32768
  ds_read_b64_tr_b16 v[90:91], v14 offset:33792
  v_mfma_f32_32x32x16_bf16 v[56:71], v[108:111], v[112:115], v[56:71]
  ds_read_b64_tr_b16 v[92:93], v15 offset:32768
  ds_read_b64_tr_b16 v[94:95], v15 offset:33792
  v_mfma_f32_32x32x16_bf16 v[72:87], v[108:111], v[116:119], v[72:87]
  v_mfma_f32_32x32x16_bf16 v[148:163], v[104:107], v[164:167], v[148:163]
  s_waitcnt lgkmcnt(0)
  v_mfma_f32_32x32x16_bf16 v[24:39], v[88:91], v[96:99], v[24:39]
  ds_read_b128 v[112:115], v17 offset:32768
  ds_read_b128 v[116:119], v17 offset:34816
  v_mfma_f32_32x32x16_bf16 v[40:55], v[88:91], v[100:103], v[40:55]
  ds_read_b64_tr_b16 v[104:105], v14 offset:36864
  ds_read_b64_tr_b16 v[106:107], v14 offset:37888
  v_mfma_f32_32x32x16_bf16 v[56:71], v[92:95], v[96:99], v[56:71]
  ds_read_b64_tr_b16 v[108:109], v15 offset:36864
  ds_read_b64_tr_b16 v[110:111], v15 offset:37888
  v_mfma_f32_32x32x16_bf16 v[72:87], v[92:95], v[100:103], v[72:87]
  v_mfma_f32_32x32x16_bf16 v[148:163], v[88:91], v[164:167], v[148:163]
  s_waitcnt lgkmcnt(0)
  s_waitcnt vmcnt(6)
  s_cmp_lg_u32 s32, 0
  s_cbranch_scc1 L_g1_rdy
  s_waitcnt vmcnt(0)
  s_mov_b32 s58, 4000
L_g1_non:
  v_readfirstlane_b32 s59, v142
  s_nop 3
  s_cmp_lg_u32 s59, 0
  s_cbranch_scc1 L_g1_non_ok
  s_sub_u32 s58, s58, 1
  s_cmp_eq_u32 s58, 0
  s_cbranch_scc1 L_g1_non_ok
  s_sleep 4
  v_mov_b32 v3, 0
  buffer_load_dword v142, v3, s[28:31], 0 offen sc1
  s_waitcnt vmcnt(0)
  s_branch L_g1_non
L_g1_non_ok:
  s_mov_b32 s58, 4000
L_g1_chk:
  v_cmp_eq_u32 vcc, s59, v22
  s_nop 3
  s_cmp_eq_u64 vcc, -1
  s_cbranch_scc1 L_g1_chk_ok
  s_sub_u32 s58, s58, 1
  s_cmp_eq_u32 s58, 0
  s_cbranch_scc1 L_g1_chk_ok
  s_sleep 8
  buffer_load_dword v22, v23, s[4:7], 0 offen sc1
  s_waitcnt vmcnt(0)
  s_branch L_g1_chk
L_g1_chk_ok:
L_g1_rdy:
  s_barrier
  v_mfma_f32_32x32x16_bf16 v[24:39], v[104:107], v[112:115], v[24:39]
  ds_read_b128 v[96:99], v20 offset:0
  ds_read_b128 v[100:103], v20 offset:2048
  v_mfma_f32_32x32x16_bf16 v[40:55], v[104:107], v[116:119], v[40:55]
  ds_read_b64_tr_b16 v[88:89], v18 offset:0
  ds_read_b64_tr_b16 v[90:91], v18 offset:1024
  v_mfma_f32_32x32x16_bf16 v[56:71], v[108:111], v[112:115], v[56:71]
  ds_read_b64_tr_b16 v[92:93], v19 offset:0
  ds_read_b64_tr_b16 v[94:95], v19 offset:1024
  v_mfma_f32_32x32x16_bf16 v[72:87], v[108:111], v[116:119], v[72:87]
  v_mfma_f32_32x32x16_bf16 v[148:163], v[104:107], v[164:167], v[148:163]
  v_and_b32 v3, 31, v2
  v_lshlrev_b32 v3, 3, v3
  s_lshl_b32 s38, s33, 7
  s_lshr_b32 s39, s32, 1
  s_lshl_b32 s39, s39, 6
  s_add_u32 s38, s38, s39
  s_lshl_b32 s38, s38, 3
  buffer_load_dwordx2 v[136:137], v3, s[20:23], s38 offen offset:0 sc1
  buffer_load_dwordx2 v[138:139], v3, s[20:23], s38 offen offset:256 sc1
  v_lshrrev_b32 v4, 2, v3
  s_and_b32 s38, s32, 1
  s_lshl_b32 s38, s38, 7
  s_lshr_b32 s39, s32, 1
  s_lshl_b32 s39, s39, 6
  s_add_u32 s38, s38, s39
  s_lshl_b32 s39, s34, 8
  s_add_u32 s38, s38, s39
  buffer_load_ushort v140, v4, s[24:27], s38 offen
  s_waitcnt lgkmcnt(0)
  v_mfma_f32_32x32x16_bf16 v[24:39], v[88:91], v[96:99], v[24:39]
  ds_read_b128 v[112:115], v21 offset:0
  ds_read_b128 v[116:119], v21 offset:2048
  v_mfma_f32_32x32x16_bf16 v[40:55], v[88:91], v[100:103], v[40:55]
  ds_read_b64_tr_b16 v[104:105], v18 offset:4096
  ds_read_b64_tr_b16 v[106:107], v18 offset:5120
  v_mfma_f32_32x32x16_bf16 v[56:71], v[92:95], v[96:99], v[56:71]
  ds_read_b64_tr_b16 v[108:109], v19 offset:4096
  ds_read_b64_tr_b16 v[110:111], v19 offset:5120
  v_mfma_f32_32x32x16_bf16 v[72:87], v[92:95], v[100:103], v[72:87]
  v_mfma_f32_32x32x16_bf16 v[148:163], v[88:91], v[164:167], v[148:163]
  s_waitcnt lgkmcnt(0)
  s_waitcnt vmcnt(2)
  s_barrier
  v_mfma_f32_32x32x16_bf16 v[24:39], v[104:107], v[112:115], v[24:39]
  ds_read_b128 v[96:99], v20 offset:16384
  ds_read_b128 v[100:103], v20 offset:18432
  v_mfma_f32_32x32x16_bf16 v[40:55], v[104:107], v[116:119], v[40:55]
  ds_read_b64_tr_b16 v[88:89], v18 offset:16384
  ds_read_b64_tr_b16 v[90:91], v18 offset:17408
  v_mfma_f32_32x32x16_bf16 v[56:71], v[108:111], v[112:115], v[56:71]
  ds_read_b64_tr_b16 v[92:93], v19 offset:16384
  ds_read_b64_tr_b16 v[94:95], v19 offset:17408
  v_mfma_f32_32x32x16_bf16 v[72:87], v[108:111], v[116:119], v[72:87]
  v_mfma_f32_32x32x16_bf16 v[148:163], v[104:107], v[164:167], v[148:163]
  s_waitcnt lgkmcnt(0)
  v_mfma_f32_32x32x16_bf16 v[24:39], v[88:91], v[96:99], v[24:39]
  ds_read_b128 v[112:115], v21 offset:16384
  ds_read_b128 v[116:119], v21 offset:18432
  v_mfma_f32_32x32x16_bf16 v[40:55], v[88:91], v[100:103], v[40:55]
  ds_read_b64_tr_b16 v[104:105], v18 offset:20480
  ds_read_b64_tr_b16 v[106:107], v18 offset:21504
  v_mfma_f32_32x32x16_bf16 v[56:71], v[92:95], v[96:99], v[56:71]
  ds_read_b64_tr_b16 v[108:109], v19 offset:20480
  ds_read_b64_tr_b16 v[110:111], v19 offset:21504
  v_mfma_f32_32x32x16_bf16 v[72:87], v[92:95], v[100:103], v[72:87]
  v_mfma_f32_32x32x16_bf16 v[148:163], v[88:91], v[164:167], v[148:163]
  s_waitcnt lgkmcnt(0)
  v_mfma_f32_32x32x16_bf16 v[24:39], v[104:107], v[112:115], v[24:39]
  v_mfma_f32_32x32x16_bf16 v[40:55], v[104:107], v[116:119], v[40:55]
  v_mfma_f32_32x32x16_bf16 v[56:71], v[108:111], v[112:115], v[56:71]
  v_mfma_f32_32x32x16_bf16 v[72:87], v[108:111], v[116:119], v[72:87]
  v_mfma_f32_32x32x16_bf16 v[148:163], v[104:107], v[164:167], v[148:163]
  v_mov_b32 v120, 3222493025
  v_mov_b32 v121, 3184710632
  v_mov_b32 v122, 1.0
  v_mov_b32 v123, 1.0
  v_bfe_u32 v8, v2, 4, 1
  v_lshlrev_b32 v8, 10, v8
  v_and_b32 v4, 15, v2
  v_lshl_add_u32 v8, v4, 4, v8
  v_lshrrev_b32 v4, 5, v2
  v_lshl_add_u32 v8, v4, 8, v8
  s_lshl_b32 s38, s33, 1
  s_lshr_b32 s39, s32, 1
  s_add_u32 s38, s38, s39
  s_mul_i32 s38, s38, 54
  s_lshl_b32 s39, s34, 2
  s_and_b32 s48, s32, 1
  s_lshl_b32 s48, s48, 1
  s_add_u32 s39, s39, s48
  s_add_u32 s38, s38, s39
  s_lshl_b32 s38, s38, 12
  s_and_b32 s46, s32, 1
  s_lshl_b32 s46, s46, 9
  s_lshr_b32 s47, s32, 1
  v_lshrrev_b32 v5, 5, v2
  v_lshlrev_b32 v5, 5, v5
  s_xor_b32 s48, s47, 0
  s_lshl_b32 s48, s48, 8
  s_add_u32 s48, s48, s46
  v_add_u32 v144, s48, v5
  s_xor_b32 s48, s47, 1
  s_lshl_b32 s48, s48, 8
  s_add_u32 s48, s48, s46
  v_add_u32 v145, s48, v5
  v_and_b32 v4, 31, v2
  v_lshrrev_b32 v6, 2, v4
  v_lshlrev_b32 v6, 5, v6
  v_and_b32 v4, 3, v4
  v_lshl_add_u32 v6, v4, 2, v6
  s_lshl_b32 s48, s47, 8
  s_add_u32 s48, s48, s46
  s_add_u32 s48, s48, 16
  v_add_u32 v6, s48, v6
  s_waitcnt vmcnt(0)
  v_lshlrev_b32 v140, 16, v140
  ds_write_b32 v6, v140
  s_mov_b32 exec_lo, 1
  s_mov_b32 exec_hi, 1
  ds_write_b128 v144, v[148:151] offset:0
  ds_write_b128 v144, v[152:155] offset:64
  ds_write_b128 v144, v[156:159] offset:128
  ds_write_b128 v144, v[160:163] offset:192
  s_mov_b64 exec, -1
  v_mul_f32 v136, v136, v137
  v_mul_f32 v138, v138, v139
  s_and_b32 s46, s2, 1
  s_lshl_b32 s46, s46, 1
  s_lshr_b32 s47, s2, 7
  s_add_u32 s46, s46, s47
  s_lshl_b32 s46, s46, 2
  s_and_b32 s47, s2, 7
  s_lshl_b32 s47, s47, 7
  s_add_u32 s46, s46, s47
  s_add_u32 s46, s46, 12292
  s_cmp_eq_u32 s32, 0
  s_cselect_b32 s46, s46, 0x7f000000
  v_mov_b32 v146, s46
  v_mov_b32 v147, 0
  s_waitcnt lgkmcnt(0)
  s_barrier
  s_cmp_ge_u32 s39, 54
  s_cbranch_scc1 L_g1_stored
  s_lshr_b32 s47, s32, 1
  s_lshl_b32 s47, s47, 12
  s_add_u32 s52, s38, s47
  s_xor_b32 s47, s47, 4096
  s_add_u32 s53, s38, s47
  ds_read_b128 v[104:107], v144 offset:0
  ds_read_b128 v[108:111], v144 offset:16
  ds_read_b128 v[112:115], v144 offset:64
  ds_read_b128 v[116:119], v144 offset:80
  s_waitcnt lgkmcnt(2)
  v_fma_f32 v88, -v136, v104, v108
  v_fma_f32 v89, -v136, v105, v109
  v_fma_f32 v90, -v136, v106, v110
  v_fma_f32 v91, -v136, v107, v111
  v_fma_f32 v92, -v138, v104, v108
  v_fma_f32 v93, -v138, v105, v109
  v_fma_f32 v94, -v138, v106, v110
  v_fma_f32 v95, -v138, v107, v111
  v_fma_f32 v24, v24, v137, v88
  v_fma_f32 v25, v25, v137, v89
  v_fma_f32 v26, v26, v137, v90
  v_fma_f32 v27, v27, v137, v91
  v_fma_f32 v40, v40, v139, v92
  v_fma_f32 v41, v41, v139, v93
  v_fma_f32 v42, v42, v139, v94
  v_fma_f32 v43, v43, v139, v95
  v_mul_f32 v96, v24, v24
  v_mul_f32 v97, v25, v25
  v_mul_f32 v98, v26, v26
  v_mul_f32 v99, v27, v27
  v_mul_f32 v100, v40, v40
  v_mul_f32 v101, v41, v41
  v_mul_f32 v102, v42, v42
  v_mul_f32 v103, v43, v43
  v_fma_f32 v96, v96, v121, v120
  v_fma_f32 v97, v97, v121, v120
  v_fma_f32 v98, v98, v121, v120
  v_fma_f32 v99, v99, v121, v120
  v_fma_f32 v100, v100, v121, v120
  v_fma_f32 v101, v101, v121, v120
  v_fma_f32 v102, v102, v121, v120
  v_fma_f32 v103, v103, v121, v120
  v_mul_f32 v88, v96, v24
  v_mul_f32 v89, v97, v25
  v_mul_f32 v90, v98, v26
  v_mul_f32 v91, v99, v27
  v_mul_f32 v92, v100, v40
  v_mul_f32 v93, v101, v41
  v_mul_f32 v94, v102, v42
  v_mul_f32 v95, v103, v43
  v_exp_f32 v88, v88
  v_exp_f32 v89, v89
  v_exp_f32 v90, v90
  v_exp_f32 v91, v91
  v_exp_f32 v92, v92
  v_exp_f32 v93, v93
  v_exp_f32 v94, v94
  v_exp_f32 v95, v95
  v_add_f32 v88, 1.0, v88
  v_add_f32 v89, 1.0, v89
  v_add_f32 v90, 1.0, v90
  v_add_f32 v91, 1.0, v91
  v_add_f32 v92, 1.0, v92
  v_add_f32 v93, 1.0, v93
  v_add_f32 v94, 1.0, v94
  v_add_f32 v95, 1.0, v95
  v_rcp_f32 v88, v88
  v_rcp_f32 v89, v89
  v_rcp_f32 v90, v90
  v_rcp_f32 v91, v91
  v_rcp_f32 v92, v92
  v_rcp_f32 v93, v93
  v_rcp_f32 v94, v94
  v_rcp_f32 v95, v95
  v_mul_f32 v24, v24, v88
  v_mul_f32 v25, v25, v89
  v_mul_f32 v26, v26, v90
  v_mul_f32 v27, v27, v91
  v_mul_f32 v40, v40, v92
  v_mul_f32 v41, v41, v93
  v_mul_f32 v42, v42, v94
  v_mul_f32 v43, v43, v95
  v_cvt_pk_bf16_f32 v24, v24, v25
  v_cvt_pk_bf16_f32 v25, v26, v27
  v_cvt_pk_bf16_f32 v40, v40, v41
  v_cvt_pk_bf16_f32 v41, v42, v43
  ds_read_b128 v[104:107], v144 offset:128
  ds_read_b128 v[108:111], v144 offset:144
  s_waitcnt lgkmcnt(2)
  v_fma_f32 v88, -v136, v112, v116
  v_fma_f32 v89, -v136, v113, v117
  v_fma_f32 v90, -v136, v114, v118
  v_fma_f32 v91, -v136, v115, v119
  v_fma_f32 v92, -v138, v112, v116
  v_fma_f32 v93, -v138, v113, v117
  v_fma_f32 v94, -v138, v114, v118
  v_fma_f32 v95, -v138, v115, v119
  v_fma_f32 v28, v28, v137, v88
  v_fma_f32 v29, v29, v137, v89
  v_fma_f32 v30, v30, v137, v90
  v_fma_f32 v31, v31, v137, v91
  v_fma_f32 v44, v44, v139, v92
  v_fma_f32 v45, v45, v139, v93
  v_fma_f32 v46, v46, v139, v94
  v_fma_f32 v47, v47, v139, v95
  v_mul_f32 v96, v28, v28
  v_mul_f32 v97, v29, v29
  v_mul_f32 v98, v30, v30
  v_mul_f32 v99, v31, v31
  v_mul_f32 v100, v44, v44
  v_mul_f32 v101, v45, v45
  v_mul_f32 v102, v46, v46
  v_mul_f32 v103, v47, v47
  v_fma_f32 v96, v96, v121, v120
  v_fma_f32 v97, v97, v121, v120
  v_fma_f32 v98, v98, v121, v120
  v_fma_f32 v99, v99, v121, v120
  v_fma_f32 v100, v100, v121, v120
  v_fma_f32 v101, v101, v121, v120
  v_fma_f32 v102, v102, v121, v120
  v_fma_f32 v103, v103, v121, v120
  v_mul_f32 v88, v96, v28
  v_mul_f32 v89, v97, v29
  v_mul_f32 v90, v98, v30
  v_mul_f32 v91, v99, v31
  v_mul_f32 v92, v100, v44
  v_mul_f32 v93, v101, v45
  v_mul_f32 v94, v102, v46
  v_mul_f32 v95, v103, v47
  v_exp_f32 v88, v88
  v_exp_f32 v89, v89
  v_exp_f32 v90, v90
  v_exp_f32 v91, v91
  v_exp_f32 v92, v92
  v_exp_f32 v93, v93
  v_exp_f32 v94, v94
  v_exp_f32 v95, v95
  v_add_f32 v88, 1.0, v88
  v_add_f32 v89, 1.0, v89
  v_add_f32 v90, 1.0, v90
  v_add_f32 v91, 1.0, v91
  v_add_f32 v92, 1.0, v92
  v_add_f32 v93, 1.0, v93
  v_add_f32 v94, 1.0, v94
  v_add_f32 v95, 1.0, v95
  v_rcp_f32 v88, v88
  v_rcp_f32 v89, v89
  v_rcp_f32 v90, v90
  v_rcp_f32 v91, v91
  v_rcp_f32 v92, v92
  v_rcp_f32 v93, v93
  v_rcp_f32 v94, v94
  v_rcp_f32 v95, v95
  v_mul_f32 v28, v28, v88
  v_mul_f32 v29, v29, v89
  v_mul_f32 v30, v30, v90
  v_mul_f32 v31, v31, v91
  v_mul_f32 v44, v44, v92
  v_mul_f32 v45, v45, v93
  v_mul_f32 v46, v46, v94
  v_mul_f32 v47, v47, v95
  v_cvt_pk_bf16_f32 v26, v28, v29
  v_cvt_pk_bf16_f32 v27, v30, v31
  v_cvt_pk_bf16_f32 v42, v44, v45
  v_cvt_pk_bf16_f32 v43, v46, v47
  buffer_store_dwordx4 v[24:27], v8, s[16:19], s52 offen offset:0 sc1
  buffer_store_dwordx4 v[40:43], v8, s[16:19], s52 offen offset:2048 sc1
  ds_read_b128 v[112:115], v144 offset:192
  ds_read_b128 v[116:119], v144 offset:208
  s_waitcnt lgkmcnt(2)
  v_fma_f32 v88, -v136, v104, v108
  v_fma_f32 v89, -v136, v105, v109
  v_fma_f32 v90, -v136, v106, v110
  v_fma_f32 v91, -v136, v107, v111
  v_fma_f32 v92, -v138, v104, v108
  v_fma_f32 v93, -v138, v105, v109
  v_fma_f32 v94, -v138, v106, v110
  v_fma_f32 v95, -v138, v107, v111
  v_fma_f32 v32, v32, v137, v88
  v_fma_f32 v33, v33, v137, v89
  v_fma_f32 v34, v34, v137, v90
  v_fma_f32 v35, v35, v137, v91
  v_fma_f32 v48, v48, v139, v92
  v_fma_f32 v49, v49, v139, v93
  v_fma_f32 v50, v50, v139, v94
  v_fma_f32 v51, v51, v139, v95
  v_mul_f32 v96, v32, v32
  v_mul_f32 v97, v33, v33
  v_mul_f32 v98, v34, v34
  v_mul_f32 v99, v35, v35
  v_mul_f32 v100, v48, v48
  v_mul_f32 v101, v49, v49
  v_mul_f32 v102, v50, v50
  v_mul_f32 v103, v51, v51
  v_fma_f32 v96, v96, v121, v120
  v_fma_f32 v97, v97, v121, v120
  v_fma_f32 v98, v98, v121, v120
  v_fma_f32 v99, v99, v121, v120
  v_fma_f32 v100, v100, v121, v120
  v_fma_f32 v101, v101, v121, v120
  v_fma_f32 v102, v102, v121, v120
  v_fma_f32 v103, v103, v121, v120
  v_mul_f32 v88, v96, v32
  v_mul_f32 v89, v97, v33
  v_mul_f32 v90, v98, v34
  v_mul_f32 v91, v99, v35
  v_mul_f32 v92, v100, v48
  v_mul_f32 v93, v101, v49
  v_mul_f32 v94, v102, v50
  v_mul_f32 v95, v103, v51
  v_exp_f32 v88, v88
  v_exp_f32 v89, v89
  v_exp_f32 v90, v90
  v_exp_f32 v91, v91
  v_exp_f32 v92, v92
  v_exp_f32 v93, v93
  v_exp_f32 v94, v94
  v_exp_f32 v95, v95
  v_add_f32 v88, 1.0, v88
  v_add_f32 v89, 1.0, v89
  v_add_f32 v90, 1.0, v90
  v_add_f32 v91, 1.0, v91
  v_add_f32 v92, 1.0, v92
  v_add_f32 v93, 1.0, v93
  v_add_f32 v94, 1.0, v94
  v_add_f32 v95, 1.0, v95
  v_rcp_f32 v88, v88
  v_rcp_f32 v89, v89
  v_rcp_f32 v90, v90
  v_rcp_f32 v91, v91
  v_rcp_f32 v92, v92
  v_rcp_f32 v93, v93
  v_rcp_f32 v94, v94
  v_rcp_f32 v95, v95
  v_mul_f32 v32, v32, v88
  v_mul_f32 v33, v33, v89
  v_mul_f32 v34, v34, v90
  v_mul_f32 v35, v35, v91
  v_mul_f32 v48, v48, v92
  v_mul_f32 v49, v49, v93
  v_mul_f32 v50, v50, v94
  v_mul_f32 v51, v51, v95
  v_cvt_pk_bf16_f32 v32, v32, v33
  v_cvt_pk_bf16_f32 v33, v34, v35
  v_cvt_pk_bf16_f32 v48, v48, v49
  v_cvt_pk_bf16_f32 v49, v50, v51
  ds_read_b128 v[104:107], v145 offset:0
  ds_read_b128 v[108:111], v145 offset:16
  s_waitcnt lgkmcnt(2)
  v_fma_f32 v88, -v136, v112, v116
  v_fma_f32 v89, -v136, v113, v117
  v_fma_f32 v90, -v136, v114, v118
  v_fma_f32 v91, -v136, v115, v119
  v_fma_f32 v92, -v138, v112, v116
  v_fma_f32 v93, -v138, v113, v117
  v_fma_f32 v94, -v138, v114, v118
  v_fma_f32 v95, -v138, v115, v119
  v_fma_f32 v36, v36, v137, v88
  v_fma_f32 v37, v37, v137, v89
  v_fma_f32 v38, v38, v137, v90
  v_fma_f32 v39, v39, v137, v91
  v_fma_f32 v52, v52, v139, v92
  v_fma_f32 v53, v53, v139, v93
  v_fma_f32 v54, v54, v139, v94
  v_fma_f32 v55, v55, v139, v95
  v_mul_f32 v96, v36, v36
  v_mul_f32 v97, v37, v37
  v_mul_f32 v98, v38, v38
  v_mul_f32 v99, v39, v39
  v_mul_f32 v100, v52, v52
  v_mul_f32 v101, v53, v53
  v_mul_f32 v102, v54, v54
  v_mul_f32 v103, v55, v55
  v_fma_f32 v96, v96, v121, v120
  v_fma_f32 v97, v97, v121, v120
  v_fma_f32 v98, v98, v121, v120
  v_fma_f32 v99, v99, v121, v120
  v_fma_f32 v100, v100, v121, v120
  v_fma_f32 v101, v101, v121, v120
  v_fma_f32 v102, v102, v121, v120
  v_fma_f32 v103, v103, v121, v120
  v_mul_f32 v88, v96, v36
  v_mul_f32 v89, v97, v37
  v_mul_f32 v90, v98, v38
  v_mul_f32 v91, v99, v39
  v_mul_f32 v92, v100, v52
  v_mul_f32 v93, v101, v53
  v_mul_f32 v94, v102, v54
  v_mul_f32 v95, v103, v55
  v_exp_f32 v88, v88
  v_exp_f32 v89, v89
  v_exp_f32 v90, v90
  v_exp_f32 v91, v91
  v_exp_f32 v92, v92
  v_exp_f32 v93, v93
  v_exp_f32 v94, v94
  v_exp_f32 v95, v95
  v_add_f32 v88, 1.0, v88
  v_add_f32 v89, 1.0, v89
  v_add_f32 v90, 1.0, v90
  v_add_f32 v91, 1.0, v91
  v_add_f32 v92, 1.0, v92
  v_add_f32 v93, 1.0, v93
  v_add_f32 v94, 1.0, v94
  v_add_f32 v95, 1.0, v95
  v_rcp_f32 v88, v88
  v_rcp_f32 v89, v89
  v_rcp_f32 v90, v90
  v_rcp_f32 v91, v91
  v_rcp_f32 v92, v92
  v_rcp_f32 v93, v93
  v_rcp_f32 v94, v94
  v_rcp_f32 v95, v95
  v_mul_f32 v36, v36, v88
  v_mul_f32 v37, v37, v89
  v_mul_f32 v38, v38, v90
  v_mul_f32 v39, v39, v91
  v_mul_f32 v52, v52, v92
  v_mul_f32 v53, v53, v93
  v_mul_f32 v54, v54, v94
  v_mul_f32 v55, v55, v95
  v_cvt_pk_bf16_f32 v34, v36, v37
  v_cvt_pk_bf16_f32 v35, v38, v39
  v_cvt_pk_bf16_f32 v50, v52, v53
  v_cvt_pk_bf16_f32 v51, v54, v55
  buffer_store_dwordx4 v[32:35], v8, s[16:19], s52 offen offset:512 sc1
  buffer_store_dwordx4 v[48:51], v8, s[16:19], s52 offen offset:2560 sc1
  ds_read_b128 v[112:115], v145 offset:64
  ds_read_b128 v[116:119], v145 offset:80
  s_waitcnt lgkmcnt(2)
  v_fma_f32 v88, -v136, v104, v108
  v_fma_f32 v89, -v136, v105, v109
  v_fma_f32 v90, -v136, v106, v110
  v_fma_f32 v91, -v136, v107, v111
  v_fma_f32 v92, -v138, v104, v108
  v_fma_f32 v93, -v138, v105, v109
  v_fma_f32 v94, -v138, v106, v110
  v_fma_f32 v95, -v138, v107, v111
  v_fma_f32 v56, v56, v137, v88
  v_fma_f32 v57, v57, v137, v89
  v_fma_f32 v58, v58, v137, v90
  v_fma_f32 v59, v59, v137, v91
  v_fma_f32 v72, v72, v139, v92
  v_fma_f32 v73, v73, v139, v93
  v_fma_f32 v74, v74, v139, v94
  v_fma_f32 v75, v75, v139, v95
  v_mul_f32 v96, v56, v56
  v_mul_f32 v97, v57, v57
  v_mul_f32 v98, v58, v58
  v_mul_f32 v99, v59, v59
  v_mul_f32 v100, v72, v72
  v_mul_f32 v101, v73, v73
  v_mul_f32 v102, v74, v74
  v_mul_f32 v103, v75, v75
  v_fma_f32 v96, v96, v121, v120
  v_fma_f32 v97, v97, v121, v120
  v_fma_f32 v98, v98, v121, v120
  v_fma_f32 v99, v99, v121, v120
  v_fma_f32 v100, v100, v121, v120
  v_fma_f32 v101, v101, v121, v120
  v_fma_f32 v102, v102, v121, v120
  v_fma_f32 v103, v103, v121, v120
  v_mul_f32 v88, v96, v56
  v_mul_f32 v89, v97, v57
  v_mul_f32 v90, v98, v58
  v_mul_f32 v91, v99, v59
  v_mul_f32 v92, v100, v72
  v_mul_f32 v93, v101, v73
  v_mul_f32 v94, v102, v74
  v_mul_f32 v95, v103, v75
  v_exp_f32 v88, v88
  v_exp_f32 v89, v89
  v_exp_f32 v90, v90
  v_exp_f32 v91, v91
  v_exp_f32 v92, v92
  v_exp_f32 v93, v93
  v_exp_f32 v94, v94
  v_exp_f32 v95, v95
  v_add_f32 v88, 1.0, v88
  v_add_f32 v89, 1.0, v89
  v_add_f32 v90, 1.0, v90
  v_add_f32 v91, 1.0, v91
  v_add_f32 v92, 1.0, v92
  v_add_f32 v93, 1.0, v93
  v_add_f32 v94, 1.0, v94
  v_add_f32 v95, 1.0, v95
  v_rcp_f32 v88, v88
  v_rcp_f32 v89, v89
  v_rcp_f32 v90, v90
  v_rcp_f32 v91, v91
  v_rcp_f32 v92, v92
  v_rcp_f32 v93, v93
  v_rcp_f32 v94, v94
  v_rcp_f32 v95, v95
  v_mul_f32 v56, v56, v88
  v_mul_f32 v57, v57, v89
  v_mul_f32 v58, v58, v90
  v_mul_f32 v59, v59, v91
  v_mul_f32 v72, v72, v92
  v_mul_f32 v73, v73, v93
  v_mul_f32 v74, v74, v94
  v_mul_f32 v75, v75, v95
  v_cvt_pk_bf16_f32 v56, v56, v57
  v_cvt_pk_bf16_f32 v57, v58, v59
  v_cvt_pk_bf16_f32 v72, v72, v73
  v_cvt_pk_bf16_f32 v73, v74, v75
  buffer_load_dword v147, v146, s[4:7], 0 offen sc1
  ds_read_b128 v[104:107], v145 offset:128
  ds_read_b128 v[108:111], v145 offset:144
  s_waitcnt lgkmcnt(2)
  v_fma_f32 v88, -v136, v112, v116
  v_fma_f32 v89, -v136, v113, v117
  v_fma_f32 v90, -v136, v114, v118
  v_fma_f32 v91, -v136, v115, v119
  v_fma_f32 v92, -v138, v112, v116
  v_fma_f32 v93, -v138, v113, v117
  v_fma_f32 v94, -v138, v114, v118
  v_fma_f32 v95, -v138, v115, v119
  v_fma_f32 v60, v60, v137, v88
  v_fma_f32 v61, v61, v137, v89
  v_fma_f32 v62, v62, v137, v90
  v_fma_f32 v63, v63, v137, v91
  v_fma_f32 v76, v76, v139, v92
  v_fma_f32 v77, v77, v139, v93
  v_fma_f32 v78, v78, v139, v94
  v_fma_f32 v79, v79, v139, v95
  v_mul_f32 v96, v60, v60
  v_mul_f32 v97, v61, v61
  v_mul_f32 v98, v62, v62
  v_mul_f32 v99, v63, v63
  v_mul_f32 v100, v76, v76
  v_mul_f32 v101, v77, v77
  v_mul_f32 v102, v78, v78
  v_mul_f32 v103, v79, v79
  v_fma_f32 v96, v96, v121, v120
  v_fma_f32 v97, v97, v121, v120
  v_fma_f32 v98, v98, v121, v120
  v_fma_f32 v99, v99, v121, v120
  v_fma_f32 v100, v100, v121, v120
  v_fma_f32 v101, v101, v121, v120
  v_fma_f32 v102, v102, v121, v120
  v_fma_f32 v103, v103, v121, v120
  v_mul_f32 v88, v96, v60
  v_mul_f32 v89, v97, v61
  v_mul_f32 v90, v98, v62
  v_mul_f32 v91, v99, v63
  v_mul_f32 v92, v100, v76
  v_mul_f32 v93, v101, v77
  v_mul_f32 v94, v102, v78
  v_mul_f32 v95, v103, v79
  v_exp_f32 v88, v88
  v_exp_f32 v89, v89
  v_exp_f32 v90, v90
  v_exp_f32 v91, v91
  v_exp_f32 v92, v92
  v_exp_f32 v93, v93
  v_exp_f32 v94, v94
  v_exp_f32 v95, v95
  v_add_f32 v88, 1.0, v88
  v_add_f32 v89, 1.0, v89
  v_add_f32 v90, 1.0, v90
  v_add_f32 v91, 1.0, v91
  v_add_f32 v92, 1.0, v92
  v_add_f32 v93, 1.0, v93
  v_add_f32 v94, 1.0, v94
  v_add_f32 v95, 1.0, v95
  v_rcp_f32 v88, v88
  v_rcp_f32 v89, v89
  v_rcp_f32 v90, v90
  v_rcp_f32 v91, v91
  v_rcp_f32 v92, v92
  v_rcp_f32 v93, v93
  v_rcp_f32 v94, v94
  v_rcp_f32 v95, v95
  v_mul_f32 v60, v60, v88
  v_mul_f32 v61, v61, v89
  v_mul_f32 v62, v62, v90
  v_mul_f32 v63, v63, v91
  v_mul_f32 v76, v76, v92
  v_mul_f32 v77, v77, v93
  v_mul_f32 v78, v78, v94
  v_mul_f32 v79, v79, v95
  v_cvt_pk_bf16_f32 v58, v60, v61
  v_cvt_pk_bf16_f32 v59, v62, v63
  v_cvt_pk_bf16_f32 v74, v76, v77
  v_cvt_pk_bf16_f32 v75, v78, v79
  buffer_store_dwordx4 v[56:59], v8, s[16:19], s53 offen offset:0 sc1
  buffer_store_dwordx4 v[72:75], v8, s[16:19], s53 offen offset:2048 sc1
  ds_read_b128 v[112:115], v145 offset:192
  ds_read_b128 v[116:119], v145 offset:208
  s_waitcnt lgkmcnt(2)
  v_fma_f32 v88, -v136, v104, v108
  v_fma_f32 v89, -v136, v105, v109
  v_fma_f32 v90, -v136, v106, v110
  v_fma_f32 v91, -v136, v107, v111
  v_fma_f32 v92, -v138, v104, v108
  v_fma_f32 v93, -v138, v105, v109
  v_fma_f32 v94, -v138, v106, v110
  v_fma_f32 v95, -v138, v107, v111
  v_fma_f32 v64, v64, v137, v88
  v_fma_f32 v65, v65, v137, v89
  v_fma_f32 v66, v66, v137, v90
  v_fma_f32 v67, v67, v137, v91
  v_fma_f32 v80, v80, v139, v92
  v_fma_f32 v81, v81, v139, v93
  v_fma_f32 v82, v82, v139, v94
  v_fma_f32 v83, v83, v139, v95
  v_mul_f32 v96, v64, v64
  v_mul_f32 v97, v65, v65
  v_mul_f32 v98, v66, v66
  v_mul_f32 v99, v67, v67
  v_mul_f32 v100, v80, v80
  v_mul_f32 v101, v81, v81
  v_mul_f32 v102, v82, v82
  v_mul_f32 v103, v83, v83
  v_fma_f32 v96, v96, v121, v120
  v_fma_f32 v97, v97, v121, v120
  v_fma_f32 v98, v98, v121, v120
  v_fma_f32 v99, v99, v121, v120
  v_fma_f32 v100, v100, v121, v120
  v_fma_f32 v101, v101, v121, v120
  v_fma_f32 v102, v102, v121, v120
  v_fma_f32 v103, v103, v121, v120
  v_mul_f32 v88, v96, v64
  v_mul_f32 v89, v97, v65
  v_mul_f32 v90, v98, v66
  v_mul_f32 v91, v99, v67
  v_mul_f32 v92, v100, v80
  v_mul_f32 v93, v101, v81
  v_mul_f32 v94, v102, v82
  v_mul_f32 v95, v103, v83
  v_exp_f32 v88, v88
  v_exp_f32 v89, v89
  v_exp_f32 v90, v90
  v_exp_f32 v91, v91
  v_exp_f32 v92, v92
  v_exp_f32 v93, v93
  v_exp_f32 v94, v94
  v_exp_f32 v95, v95
  v_add_f32 v88, 1.0, v88
  v_add_f32 v89, 1.0, v89
  v_add_f32 v90, 1.0, v90
  v_add_f32 v91, 1.0, v91
  v_add_f32 v92, 1.0, v92
  v_add_f32 v93, 1.0, v93
  v_add_f32 v94, 1.0, v94
  v_add_f32 v95, 1.0, v95
  v_rcp_f32 v88, v88
  v_rcp_f32 v89, v89
  v_rcp_f32 v90, v90
  v_rcp_f32 v91, v91
  v_rcp_f32 v92, v92
  v_rcp_f32 v93, v93
  v_rcp_f32 v94, v94
  v_rcp_f32 v95, v95
  v_mul_f32 v64, v64, v88
  v_mul_f32 v65, v65, v89
  v_mul_f32 v66, v66, v90
  v_mul_f32 v67, v67, v91
  v_mul_f32 v80, v80, v92
  v_mul_f32 v81, v81, v93
  v_mul_f32 v82, v82, v94
  v_mul_f32 v83, v83, v95
  v_cvt_pk_bf16_f32 v64, v64, v65
  v_cvt_pk_bf16_f32 v65, v66, v67
  v_cvt_pk_bf16_f32 v80, v80, v81
  v_cvt_pk_bf16_f32 v81, v82, v83
  s_waitcnt lgkmcnt(0)
  v_fma_f32 v88, -v136, v112, v116
  v_fma_f32 v89, -v136, v113, v117
  v_fma_f32 v90, -v136, v114, v118
  v_fma_f32 v91, -v136, v115, v119
  v_fma_f32 v92, -v138, v112, v116
  v_fma_f32 v93, -v138, v113, v117
  v_fma_f32 v94, -v138, v114, v118
  v_fma_f32 v95, -v138, v115, v119
  v_fma_f32 v68, v68, v137, v88
  v_fma_f32 v69, v69, v137, v89
  v_fma_f32 v70, v70, v137, v90
  v_fma_f32 v71, v71, v137, v91
  v_fma_f32 v84, v84, v139, v92
  v_fma_f32 v85, v85, v139, v93
  v_fma_f32 v86, v86, v139, v94
  v_fma_f32 v87, v87, v139, v95
  v_mul_f32 v96, v68, v68
  v_mul_f32 v97, v69, v69
  v_mul_f32 v98, v70, v70
  v_mul_f32 v99, v71, v71
  v_mul_f32 v100, v84, v84
  v_mul_f32 v101, v85, v85
  v_mul_f32 v102, v86, v86
  v_mul_f32 v103, v87, v87
  v_fma_f32 v96, v96, v121, v120
  v_fma_f32 v97, v97, v121, v120
  v_fma_f32 v98, v98, v121, v120
  v_fma_f32 v99, v99, v121, v120
  v_fma_f32 v100, v100, v121, v120
  v_fma_f32 v101, v101, v121, v120
  v_fma_f32 v102, v102, v121, v120
  v_fma_f32 v103, v103, v121, v120
  v_mul_f32 v88, v96, v68
  v_mul_f32 v89, v97, v69
  v_mul_f32 v90, v98, v70
  v_mul_f32 v91, v99, v71
  v_mul_f32 v92, v100, v84
  v_mul_f32 v93, v101, v85
  v_mul_f32 v94, v102, v86
  v_mul_f32 v95, v103, v87
  v_exp_f32 v88, v88
  v_exp_f32 v89, v89
  v_exp_f32 v90, v90
  v_exp_f32 v91, v91
  v_exp_f32 v92, v92
  v_exp_f32 v93, v93
  v_exp_f32 v94, v94
  v_exp_f32 v95, v95
  v_add_f32 v88, 1.0, v88
  v_add_f32 v89, 1.0, v89
  v_add_f32 v90, 1.0, v90
  v_add_f32 v91, 1.0, v91
  v_add_f32 v92, 1.0, v92
  v_add_f32 v93, 1.0, v93
  v_add_f32 v94, 1.0, v94
  v_add_f32 v95, 1.0, v95
  v_rcp_f32 v88, v88
  v_rcp_f32 v89, v89
  v_rcp_f32 v90, v90
  v_rcp_f32 v91, v91
  v_rcp_f32 v92, v92
  v_rcp_f32 v93, v93
  v_rcp_f32 v94, v94
  v_rcp_f32 v95, v95
  v_mul_f32 v68, v68, v88
  v_mul_f32 v69, v69, v89
  v_mul_f32 v70, v70, v90
  v_mul_f32 v71, v71, v91
  v_mul_f32 v84, v84, v92
  v_mul_f32 v85, v85, v93
  v_mul_f32 v86, v86, v94
  v_mul_f32 v87, v87, v95
  v_cvt_pk_bf16_f32 v66, v68, v69
  v_cvt_pk_bf16_f32 v67, v70, v71
  v_cvt_pk_bf16_f32 v82, v84, v85
  v_cvt_pk_bf16_f32 v83, v86, v87
  buffer_store_dwordx4 v[64:67], v8, s[16:19], s53 offen offset:512 sc1
  buffer_store_dwordx4 v[80:83], v8, s[16:19], s53 offen offset:2560 sc1
L_g1_stored:
  s_lshl_b32 s57, s33, 7
  s_lshl_b32 s39, s34, 2
  s_add_u32 s57, s57, s39
  s_add_u32 s57, s57, 4608
  s_branch L_G2
L_LN:
  s_setprio 2
  s_cmp_lg_u32 s2, 255
  s_cbranch_scc1 L_LN2
  s_cmp_lg_u32 s32, 0
  s_cbranch_scc1 L_LN2
  s_memrealtime s[60:61]
  s_waitcnt lgkmcnt(0)
  s_or_b32 s60, s60, 1
  s_mov_b32 s28, s90
  s_mov_b32 s29, s91
  s_mov_b32 s30, 256
  s_mov_b32 s31, 0x00020000
  v_mov_b32 v3, 0
  v_mov_b32 v4, s60
  s_mov_b64 exec, 1
  buffer_store_dword v4, v3, s[28:31], 0 offen sc1
  s_mov_b64 exec, -1
L_LN2:
  s_and_b32 s33, s2, 7
  s_lshr_b32 s34, s33, 1
  s_lshl_b32 s34, s34, 4
  s_and_b32 s33, s33, 1
  s_lshl_b32 s33, s33, 3
  s_add_u32 s34, s34, s33
  s_sub_u32 s33, s62, 224
  s_lshr_b32 s33, s33, 3
  s_add_u32 s34, s34, s33
  s_lshr_b32 s33, s2, 8
  s_lshl_b32 s33, s33, 2
  s_add_u32 s61, s34, s33
  v_lshrrev_b32 v3, 4, v2
  v_and_b32 v4, 15, v2
  s_lshl_b32 s33, s61, 5
  s_lshl_b32 s34, s32, 3
  s_add_u32 s33, s33, s34
  s_mul_i32 s34, s33, 1280
  v_mul_u32_u24 v5, 2560, v3
  v_lshl_add_u32 v5, v4, 4, v5
  s_waitcnt lgkmcnt(0)
  s_mov_b32 s8, s64
  s_mov_b32 s9, s65
  s_mov_b32 s10, 2621440
  s_mov_b32 s11, 0x00020000
  buffer_load_dwordx4 v[8:11], v5, s[8:11], s34 offen offset:0
  buffer_load_dwordx4 v[12:15], v5, s[8:11], s34 offen offset:256
  buffer_load_dwordx4 v[16:19], v5, s[8:11], s34 offen offset:512
  buffer_load_dwordx4 v[20:23], v5, s[8:11], s34 offen offset:768
  buffer_load_dwordx4 v[24:27], v5, s[8:11], s34 offen offset:1024
  buffer_load_dwordx4 v[28:31], v5, s[8:11], s34 offen offset:1280
  buffer_load_dwordx4 v[32:35], v5, s[8:11], s34 offen offset:1536
  buffer_load_dwordx4 v[36:39], v5, s[8:11], s34 offen offset:1792
  buffer_load_dwordx4 v[40:43], v5, s[8:11], s34 offen offset:2048
  buffer_load_dwordx4 v[44:47], v5, s[8:11], s34 offen offset:2304
  s_mov_b32 s57, s33
  s_mov_b32 s33, s57
  s_mov_b32 s28, s90
  s_mov_b32 s29, s91
  s_mov_b32 s30, 256
  s_mov_b32 s31, 0x00020000
  v_mov_b32 v151, 0
  buffer_load_dword v150, v151, s[28:31], 0 offen sc1
  s_add_u32 s12, s92, 7340032
  s_addc_u32 s13, s93, 0
  s_mov_b32 s14, 2621440
  s_mov_b32 s15, 0x00020000
  s_add_u32 s16, s92, 19922944
  s_addc_u32 s17, s93, 0
  s_mov_b32 s18, 16384
  s_mov_b32 s19, 0x00020000
  s_add_u32 s4, s92, 20185088
  s_addc_u32 s5, s93, 0
  s_mov_b32 s6, 16384
  s_mov_b32 s7, 0x00020000
  s_waitcnt vmcnt(10)
  v_lshlrev_b32 v48, 16, v8
  v_and_b32 v49, 0xffff0000, v8
  v_lshlrev_b32 v50, 16, v9
  v_and_b32 v51, 0xffff0000, v9
  v_lshlrev_b32 v52, 16, v10
  v_and_b32 v53, 0xffff0000, v10
  v_lshlrev_b32 v54, 16, v11
  v_and_b32 v55, 0xffff0000, v11
  v_add_f32 v136, v48, v50
  v_add_f32 v137, v49, v51
  v_add_f32 v136, v136, v52
  v_add_f32 v137, v137, v53
  v_add_f32 v136, v136, v54
  v_add_f32 v137, v137, v55
  s_waitcnt vmcnt(9)
  v_lshlrev_b32 v56, 16, v12
  v_and_b32 v57, 0xffff0000, v12
  v_lshlrev_b32 v58, 16, v13
  v_and_b32 v59, 0xffff0000, v13
  v_lshlrev_b32 v60, 16, v14
  v_and_b32 v61, 0xffff0000, v14
  v_lshlrev_b32 v62, 16, v15
  v_and_b32 v63, 0xffff0000, v15
  v_add_f32 v136, v136, v56
  v_add_f32 v137, v137, v57
  v_add_f32 v136, v136, v58
  v_add_f32 v137, v137, v59
  v_add_f32 v136, v136, v60
  v_add_f32 v137, v137, v61
  v_add_f32 v136, v136, v62
  v_add_f32 v137, v137, v63
  s_waitcnt vmcnt(8)
  v_lshlrev_b32 v64, 16, v16
  v_and_b32 v65, 0xffff0000, v16
  v_lshlrev_b32 v66, 16, v17
  v_and_b32 v67, 0xffff0000, v17
  v_lshlrev_b32 v68, 16, v18
  v_and_b32 v69, 0xffff0000, v18
  v_lshlrev_b32 v70, 16, v19
  v_and_b32 v71, 0xffff0000, v19
  v_add_f32 v136, v136, v64
  v_add_f32 v137, v137, v65
  v_add_f32 v136, v136, v66
  v_add_f32 v137, v137, v67
  v_add_f32 v136, v136, v68
  v_add_f32 v137, v137, v69
  v_add_f32 v136, v136, v70
  v_add_f32 v137, v137, v71
  s_waitcnt vmcnt(7)
  v_lshlrev_b32 v72, 16, v20
  v_and_b32 v73, 0xffff0000, v20
  v_lshlrev_b32 v74, 16, v21
  v_and_b32 v75, 0xffff0000, v21
  v_lshlrev_b32 v76, 16, v22
  v_and_b32 v77, 0xffff0000, v22
  v_lshlrev_b32 v78, 16, v23
  v_and_b32 v79, 0xffff0000, v23
  v_add_f32 v136, v136, v72
  v_add_f32 v137, v137, v73
  v_add_f32 v136, v136, v74
  v_add_f32 v137, v137, v75
  v_add_f32 v136, v136, v76
  v_add_f32 v137, v137, v77
  v_add_f32 v136, v136, v78
  v_add_f32 v137, v137, v79
  s_waitcnt vmcnt(6)
  v_lshlrev_b32 v80, 16, v24
  v_and_b32 v81, 0xffff0000, v24
  v_lshlrev_b32 v82, 16, v25
  v_and_b32 v83, 0xffff0000, v25
  v_lshlrev_b32 v84, 16, v26
  v_and_b32 v85, 0xffff0000, v26
  v_lshlrev_b32 v86, 16, v27
  v_and_b32 v87, 0xffff0000, v27
  v_add_f32 v136, v136, v80
  v_add_f32 v137, v137, v81
  v_add_f32 v136, v136, v82
  v_add_f32 v137, v137, v83
  v_add_f32 v136, v136, v84
  v_add_f32 v137, v137, v85
  v_add_f32 v136, v136, v86
  v_add_f32 v137, v137, v87
  s_waitcnt vmcnt(5)
  v_lshlrev_b32 v88, 16, v28
  v_and_b32 v89, 0xffff0000, v28
  v_lshlrev_b32 v90, 16, v29
  v_and_b32 v91, 0xffff0000, v29
  v_lshlrev_b32 v92, 16, v30
  v_and_b32 v93, 0xffff0000, v30
  v_lshlrev_b32 v94, 16, v31
  v_and_b32 v95, 0xffff0000, v31
  v_add_f32 v138, v88, v90
  v_add_f32 v139, v89, v91
  v_add_f32 v138, v138, v92
  v_add_f32 v139, v139, v93
  v_add_f32 v138, v138, v94
  v_add_f32 v139, v139, v95
  s_waitcnt vmcnt(4)
  v_lshlrev_b32 v96, 16, v32
  v_and_b32 v97, 0xffff0000, v32
  v_lshlrev_b32 v98, 16, v33
  v_and_b32 v99, 0xffff0000, v33
  v_lshlrev_b32 v100, 16, v34
  v_and_b32 v101, 0xffff0000, v34
  v_lshlrev_b32 v102, 16, v35
  v_and_b32 v103, 0xffff0000, v35
  v_add_f32 v138, v138, v96
  v_add_f32 v139, v139, v97
  v_add_f32 v138, v138, v98
  v_add_f32 v139, v139, v99
  v_add_f32 v138, v138, v100
  v_add_f32 v139, v139, v101
  v_add_f32 v138, v138, v102
  v_add_f32 v139, v139, v103
  s_waitcnt vmcnt(3)
  v_lshlrev_b32 v104, 16, v36
  v_and_b32 v105, 0xffff0000, v36
  v_lshlrev_b32 v106, 16, v37
  v_and_b32 v107, 0xffff0000, v37
  v_lshlrev_b32 v108, 16, v38
  v_and_b32 v109, 0xffff0000, v38
  v_lshlrev_b32 v110, 16, v39
  v_and_b32 v111, 0xffff0000, v39
  v_add_f32 v138, v138, v104
  v_add_f32 v139, v139, v105
  v_add_f32 v138, v138, v106
  v_add_f32 v139, v139, v107
  v_add_f32 v138, v138, v108
  v_add_f32 v139, v139, v109
  v_add_f32 v138, v138, v110
  v_add_f32 v139, v139, v111
  s_waitcnt vmcnt(2)
  v_lshlrev_b32 v112, 16, v40
  v_and_b32 v113, 0xffff0000, v40
  v_lshlrev_b32 v114, 16, v41
  v_and_b32 v115, 0xffff0000, v41
  v_lshlrev_b32 v116, 16, v42
  v_and_b32 v117, 0xffff0000, v42
  v_lshlrev_b32 v118, 16, v43
  v_and_b32 v119, 0xffff0000, v43
  v_add_f32 v138, v138, v112
  v_add_f32 v139, v139, v113
  v_add_f32 v138, v138, v114
  v_add_f32 v139, v139, v115
  v_add_f32 v138, v138, v116
  v_add_f32 v139, v139, v117
  v_add_f32 v138, v138, v118
  v_add_f32 v139, v139, v119
  s_waitcnt vmcnt(1)
  v_lshlrev_b32 v120, 16, v44
  v_and_b32 v121, 0xffff0000, v44
  v_lshlrev_b32 v122, 16, v45
  v_and_b32 v123, 0xffff0000, v45
  v_lshlrev_b32 v124, 16, v46
  v_and_b32 v125, 0xffff0000, v46
  v_lshlrev_b32 v126, 16, v47
  v_and_b32 v127, 0xffff0000, v47
  v_add_f32 v138, v138, v120
  v_add_f32 v139, v139, v121
  v_add_f32 v138, v138, v122
  v_add_f32 v139, v139, v123
  v_add_f32 v138, v138, v124
  v_add_f32 v139, v139, v125
  v_add_f32 v138, v138, v126
  v_add_f32 v139, v139, v127
  s_mov_b32 s33, s57
  v_add_f32 v128, v136, v137
  v_add_f32 v129, v138, v139
  s_nop 0
  v_add_f32_dpp v128, v128, v128 row_ror:8 row_mask:0xf bank_mask:0xf
  s_nop 0
  v_add_f32_dpp v129, v129, v129 row_ror:8 row_mask:0xf bank_mask:0xf
  s_nop 0
  v_add_f32_dpp v128, v128, v128 row_ror:4 row_mask:0xf bank_mask:0xf
  s_nop 0
  v_add_f32_dpp v129, v129, v129 row_ror:4 row_mask:0xf bank_mask:0xf
  s_nop 0
  v_add_f32_dpp v128, v128, v128 row_ror:2 row_mask:0xf bank_mask:0xf
  s_nop 0
  v_add_f32_dpp v129, v129, v129 row_ror:2 row_mask:0xf bank_mask:0xf
  s_nop 0
  v_add_f32_dpp v128, v128, v128 row_ror:1 row_mask:0xf bank_mask:0xf
  s_nop 0
  v_add_f32_dpp v129, v129, v129 row_ror:1 row_mask:0xf bank_mask:0xf
  s_mov_b32 s35, 986500301
  v_mul_f32 v128, s35, v128
  v_mul_f32 v129, s35, v129
  v_mov_b32 v136, 0
  v_mov_b32 v137, 0
  v_mov_b32 v138, 0
  v_mov_b32 v139, 0
  v_mov_b32 v140, 0
  v_mov_b32 v141, 0
  v_mov_b32 v142, 0
  v_mov_b32 v143, 0
  v_sub_f32 v144, v48, v128
  v_sub_f32 v145, v49, v128
  v_sub_f32 v146, v88, v129
  v_sub_f32 v147, v89, v129
  v_fmac_f32 v136, v144, v144
  v_fmac_f32 v137, v145, v145
  v_fmac_f32 v140, v146, v146
  v_fmac_f32 v141, v147, v147
  v_sub_f32 v144, v50, v128
  v_sub_f32 v145, v51, v128
  v_sub_f32 v146, v90, v129
  v_sub_f32 v147, v91, v129
  v_fmac_f32 v138, v144, v144
  v_fmac_f32 v139, v145, v145
  v_fmac_f32 v142, v146, v146
  v_fmac_f32 v143, v147, v147
  v_sub_f32 v144, v52, v128
  v_sub_f32 v145, v53, v128
  v_sub_f32 v146, v92, v129
  v_sub_f32 v147, v93, v129
  v_fmac_f32 v136, v144, v144
  v_fmac_f32 v137, v145, v145
  v_fmac_f32 v140, v146, v146
  v_fmac_f32 v141, v147, v147
  v_sub_f32 v144, v54, v128
  v_sub_f32 v145, v55, v128
  v_sub_f32 v146, v94, v129
  v_sub_f32 v147, v95, v129
  v_fmac_f32 v138, v144, v144
  v_fmac_f32 v139, v145, v145
  v_fmac_f32 v142, v146, v146
  v_fmac_f32 v143, v147, v147
  v_sub_f32 v144, v56, v128
  v_sub_f32 v145, v57, v128
  v_sub_f32 v146, v96, v129
  v_sub_f32 v147, v97, v129
  v_fmac_f32 v136, v144, v144
  v_fmac_f32 v137, v145, v145
  v_fmac_f32 v140, v146, v146
  v_fmac_f32 v141, v147, v147
  v_sub_f32 v144, v58, v128
  v_sub_f32 v145, v59, v128
  v_sub_f32 v146, v98, v129
  v_sub_f32 v147, v99, v129
  v_fmac_f32 v138, v144, v144
  v_fmac_f32 v139, v145, v145
  v_fmac_f32 v142, v146, v146
  v_fmac_f32 v143, v147, v147
  v_sub_f32 v144, v60, v128
  v_sub_f32 v145, v61, v128
  v_sub_f32 v146, v100, v129
  v_sub_f32 v147, v101, v129
  v_fmac_f32 v136, v144, v144
  v_fmac_f32 v137, v145, v145
  v_fmac_f32 v140, v146, v146
  v_fmac_f32 v141, v147, v147
  v_sub_f32 v144, v62, v128
  v_sub_f32 v145, v63, v128
  v_sub_f32 v146, v102, v129
  v_sub_f32 v147, v103, v129
  v_fmac_f32 v138, v144, v144
  v_fmac_f32 v139, v145, v145
  v_fmac_f32 v142, v146, v146
  v_fmac_f32 v143, v147, v147
  v_sub_f32 v144, v64, v128
  v_sub_f32 v145, v65, v128
  v_sub_f32 v146, v104, v129
  v_sub_f32 v147, v105, v129
  v_fmac_f32 v136, v144, v144
  v_fmac_f32 v137, v145, v145
  v_fmac_f32 v140, v146, v146
  v_fmac_f32 v141, v147, v147
  v_sub_f32 v144, v66, v128
  v_sub_f32 v145, v67, v128
  v_sub_f32 v146, v106, v129
  v_sub_f32 v147, v107, v129
  v_fmac_f32 v138, v144, v144
  v_fmac_f32 v139, v145, v145
  v_fmac_f32 v142, v146, v146
  v_fmac_f32 v143, v147, v147
  v_sub_f32 v144, v68, v128
  v_sub_f32 v145, v69, v128
  v_sub_f32 v146, v108, v129
  v_sub_f32 v147, v109, v129
  v_fmac_f32 v136, v144, v144
  v_fmac_f32 v137, v145, v145
  v_fmac_f32 v140, v146, v146
  v_fmac_f32 v141, v147, v147
  v_sub_f32 v144, v70, v128
  v_sub_f32 v145, v71, v128
  v_sub_f32 v146, v110, v129
  v_sub_f32 v147, v111, v129
  v_fmac_f32 v138, v144, v144
  v_fmac_f32 v139, v145, v145
  v_fmac_f32 v142, v146, v146
  v_fmac_f32 v143, v147, v147
  v_sub_f32 v144, v72, v128
  v_sub_f32 v145, v73, v128
  v_sub_f32 v146, v112, v129
  v_sub_f32 v147, v113, v129
  v_fmac_f32 v136, v144, v144
  v_fmac_f32 v137, v145, v145
  v_fmac_f32 v140, v146, v146
  v_fmac_f32 v141, v147, v147
  v_sub_f32 v144, v74, v128
  v_sub_f32 v145, v75, v128
  v_sub_f32 v146, v114, v129
  v_sub_f32 v147, v115, v129
  v_fmac_f32 v138, v144, v144
  v_fmac_f32 v139, v145, v145
  v_fmac_f32 v142, v146, v146
  v_fmac_f32 v143, v147, v147
  v_sub_f32 v144, v76, v128
  v_sub_f32 v145, v77, v128
  v_sub_f32 v146, v116, v129
  v_sub_f32 v147, v117, v129
  v_fmac_f32 v136, v144, v144
  v_fmac_f32 v137, v145, v145
  v_fmac_f32 v140, v146, v146
  v_fmac_f32 v141, v147, v147
  v_sub_f32 v144, v78, v128
  v_sub_f32 v145, v79, v128
  v_sub_f32 v146, v118, v129
  v_sub_f32 v147, v119, v129
  v_fmac_f32 v138, v144, v144
  v_fmac_f32 v139, v145, v145
  v_fmac_f32 v142, v146, v146
  v_fmac_f32 v143, v147, v147
  v_sub_f32 v144, v80, v128
  v_sub_f32 v145, v81, v128
  v_sub_f32 v146, v120, v129
  v_sub_f32 v147, v121, v129
  v_fmac_f32 v136, v144, v144
  v_fmac_f32 v137, v145, v145
  v_fmac_f32 v140, v146, v146
  v_fmac_f32 v141, v147, v147
  v_sub_f32 v144, v82, v128
  v_sub_f32 v145, v83, v128
  v_sub_f32 v146, v122, v129
  v_sub_f32 v147, v123, v129
  v_fmac_f32 v138, v144, v144
  v_fmac_f32 v139, v145, v145
  v_fmac_f32 v142, v146, v146
  v_fmac_f32 v143, v147, v147
  v_sub_f32 v144, v84, v128
  v_sub_f32 v145, v85, v128
  v_sub_f32 v146, v124, v129
  v_sub_f32 v147, v125, v129
  v_fmac_f32 v136, v144, v144
  v_fmac_f32 v137, v145, v145
  v_fmac_f32 v140, v146, v146
  v_fmac_f32 v141, v147, v147
  v_sub_f32 v144, v86, v128
  v_sub_f32 v145, v87, v128
  v_sub_f32 v146, v126, v129
  v_sub_f32 v147, v127, v129
  v_fmac_f32 v138, v144, v144
  v_fmac_f32 v139, v145, v145
  v_fmac_f32 v142, v146, v146
  v_fmac_f32 v143, v147, v147
  v_add_f32 v136, v136, v138
  v_add_f32 v137, v137, v139
  v_add_f32 v130, v136, v137
  v_add_f32 v140, v140, v142
  v_add_f32 v141, v141, v143
  v_add_f32 v131, v140, v141
  v_add_f32_dpp v130, v130, v130 row_ror:8 row_mask:0xf bank_mask:0xf
  s_nop 0
  v_add_f32_dpp v131, v131, v131 row_ror:8 row_mask:0xf bank_mask:0xf
  s_nop 0
  v_add_f32_dpp v130, v130, v130 row_ror:4 row_mask:0xf bank_mask:0xf
  s_nop 0
  v_add_f32_dpp v131, v131, v131 row_ror:4 row_mask:0xf bank_mask:0xf
  s_nop 0
  v_add_f32_dpp v130, v130, v130 row_ror:2 row_mask:0xf bank_mask:0xf
  s_nop 0
  v_add_f32_dpp v131, v131, v131 row_ror:2 row_mask:0xf bank_mask:0xf
  s_nop 0
  v_add_f32_dpp v130, v130, v130 row_ror:1 row_mask:0xf bank_mask:0xf
  s_nop 0
  v_add_f32_dpp v131, v131, v131 row_ror:1 row_mask:0xf bank_mask:0xf
  v_mul_f32 v130, s35, v130
  v_mul_f32 v131, s35, v131
  v_cvt_pk_bf16_f32 v130, v130, v130
  v_cvt_pk_bf16_f32 v131, v131, v131
  v_and_b32 v130, 0xffff0000, v130
  v_and_b32 v131, 0xffff0000, v131
  v_add_f32 v130, 0x3727c5ac, v130
  v_add_f32 v131, 0x3727c5ac, v131
  v_cvt_pk_bf16_f32 v130, v130, v130
  v_cvt_pk_bf16_f32 v131, v131, v131
  v_and_b32 v130, 0xffff0000, v130
  v_and_b32 v131, 0xffff0000, v131
  v_sqrt_f32 v130, v130
  v_sqrt_f32 v131, v131
  v_cvt_pk_bf16_f32 v130, v130, v130
  v_cvt_pk_bf16_f32 v131, v131, v131
  v_and_b32 v130, 0xffff0000, v130
  v_and_b32 v131, 0xffff0000, v131
  v_rcp_f32 v130, v130
  v_rcp_f32 v131, v131
  v_cvt_pk_bf16_f32 v128, v128, v128
  v_cvt_pk_bf16_f32 v129, v129, v129
  v_and_b32 v128, 0xffff0000, v128
  v_and_b32 v129, 0xffff0000, v129
  v_mov_b32 v136, v128
  v_mov_b32 v137, v130
  v_mov_b32 v138, v129
  v_mov_b32 v139, v131
  v_lshlrev_b32 v140, 4, v3
  v_cmp_eq_u32 vcc, 0, v4
  v_mov_b32 v141, 0x7f000000
  s_nop 0
  v_cndmask_b32 v140, v141, v140, vcc
  s_lshl_b32 s36, s33, 3
  buffer_store_dwordx4 v[136:139], v140, s[16:19], s36 offen sc1
  v_mul_f32 v132, v128, v130
  v_mul_f32 v133, v129, v131
  v_mul_u32_u24 v144, 520, v4
  v_lshl_add_u32 v144, v3, 2, v144
  s_lshl_b32 s37, s32, 4
  v_add_u32 v144, s37, v144
  v_fma_f32 v48, v48, v130, -v132
  v_fma_f32 v88, v88, v131, -v133
  v_fma_f32 v49, v49, v130, -v132
  v_fma_f32 v89, v89, v131, -v133
  v_fma_f32 v50, v50, v130, -v132
  v_fma_f32 v90, v90, v131, -v133
  v_fma_f32 v51, v51, v130, -v132
  v_fma_f32 v91, v91, v131, -v133
  v_fma_f32 v52, v52, v130, -v132
  v_fma_f32 v92, v92, v131, -v133
  v_fma_f32 v53, v53, v130, -v132
  v_fma_f32 v93, v93, v131, -v133
  v_fma_f32 v54, v54, v130, -v132
  v_fma_f32 v94, v94, v131, -v133
  v_fma_f32 v55, v55, v130, -v132
  v_fma_f32 v95, v95, v131, -v133
  v_cvt_pk_bf16_f32 v48, v48, v88
  v_cvt_pk_bf16_f32 v49, v49, v89
  v_cvt_pk_bf16_f32 v50, v50, v90
  v_cvt_pk_bf16_f32 v51, v51, v91
  v_cvt_pk_bf16_f32 v52, v52, v92
  v_cvt_pk_bf16_f32 v53, v53, v93
  v_cvt_pk_bf16_f32 v54, v54, v94
  v_cvt_pk_bf16_f32 v55, v55, v95
  v_fma_f32 v56, v56, v130, -v132
  v_fma_f32 v96, v96, v131, -v133
  v_fma_f32 v57, v57, v130, -v132
  v_fma_f32 v97, v97, v131, -v133
  v_fma_f32 v58, v58, v130, -v132
  v_fma_f32 v98, v98, v131, -v133
  v_fma_f32 v59, v59, v130, -v132
  v_fma_f32 v99, v99, v131, -v133
  v_fma_f32 v60, v60, v130, -v132
  v_fma_f32 v100, v100, v131, -v133
  v_fma_f32 v61, v61, v130, -v132
  v_fma_f32 v101, v101, v131, -v133
  v_fma_f32 v62, v62, v130, -v132
  v_fma_f32 v102, v102, v131, -v133
  v_fma_f32 v63, v63, v130, -v132
  v_fma_f32 v103, v103, v131, -v133
  v_cvt_pk_bf16_f32 v56, v56, v96
  v_cvt_pk_bf16_f32 v57, v57, v97
  v_cvt_pk_bf16_f32 v58, v58, v98
  v_cvt_pk_bf16_f32 v59, v59, v99
  v_cvt_pk_bf16_f32 v60, v60, v100
  v_cvt_pk_bf16_f32 v61, v61, v101
  v_cvt_pk_bf16_f32 v62, v62, v102
  v_cvt_pk_bf16_f32 v63, v63, v103
  v_fma_f32 v64, v64, v130, -v132
  v_fma_f32 v104, v104, v131, -v133
  v_fma_f32 v65, v65, v130, -v132
  v_fma_f32 v105, v105, v131, -v133
  v_fma_f32 v66, v66, v130, -v132
  v_fma_f32 v106, v106, v131, -v133
  v_fma_f32 v67, v67, v130, -v132
  v_fma_f32 v107, v107, v131, -v133
  v_fma_f32 v68, v68, v130, -v132
  v_fma_f32 v108, v108, v131, -v133
  v_fma_f32 v69, v69, v130, -v132
  v_fma_f32 v109, v109, v131, -v133
  v_fma_f32 v70, v70, v130, -v132
  v_fma_f32 v110, v110, v131, -v133
  v_fma_f32 v71, v71, v130, -v132
  v_fma_f32 v111, v111, v131, -v133
  v_cvt_pk_bf16_f32 v64, v64, v104
  v_cvt_pk_bf16_f32 v65, v65, v105
  v_cvt_pk_bf16_f32 v66, v66, v106
  v_cvt_pk_bf16_f32 v67, v67, v107
  v_cvt_pk_bf16_f32 v68, v68, v108
  v_cvt_pk_bf16_f32 v69, v69, v109
  v_cvt_pk_bf16_f32 v70, v70, v110
  v_cvt_pk_bf16_f32 v71, v71, v111
  v_fma_f32 v72, v72, v130, -v132
  v_fma_f32 v112, v112, v131, -v133
  v_fma_f32 v73, v73, v130, -v132
  v_fma_f32 v113, v113, v131, -v133
  v_fma_f32 v74, v74, v130, -v132
  v_fma_f32 v114, v114, v131, -v133
  v_fma_f32 v75, v75, v130, -v132
  v_fma_f32 v115, v115, v131, -v133
  v_fma_f32 v76, v76, v130, -v132
  v_fma_f32 v116, v116, v131, -v133
  v_fma_f32 v77, v77, v130, -v132
  v_fma_f32 v117, v117, v131, -v133
  v_fma_f32 v78, v78, v130, -v132
  v_fma_f32 v118, v118, v131, -v133
  v_fma_f32 v79, v79, v130, -v132
  v_fma_f32 v119, v119, v131, -v133
  v_cvt_pk_bf16_f32 v72, v72, v112
  v_cvt_pk_bf16_f32 v73, v73, v113
  v_cvt_pk_bf16_f32 v74, v74, v114
  v_cvt_pk_bf16_f32 v75, v75, v115
  v_cvt_pk_bf16_f32 v76, v76, v116
  v_cvt_pk_bf16_f32 v77, v77, v117
  v_cvt_pk_bf16_f32 v78, v78, v118
  v_cvt_pk_bf16_f32 v79, v79, v119
  v_fma_f32 v80, v80, v130, -v132
  v_fma_f32 v120, v120, v131, -v133
  v_fma_f32 v81, v81, v130, -v132
  v_fma_f32 v121, v121, v131, -v133
  v_fma_f32 v82, v82, v130, -v132
  v_fma_f32 v122, v122, v131, -v133
  v_fma_f32 v83, v83, v130, -v132
  v_fma_f32 v123, v123, v131, -v133
  v_fma_f32 v84, v84, v130, -v132
  v_fma_f32 v124, v124, v131, -v133
  v_fma_f32 v85, v85, v130, -v132
  v_fma_f32 v125, v125, v131, -v133
  v_fma_f32 v86, v86, v130, -v132
  v_fma_f32 v126, v126, v131, -v133
  v_fma_f32 v87, v87, v130, -v132
  v_fma_f32 v127, v127, v131, -v133
  v_cvt_pk_bf16_f32 v80, v80, v120
  v_cvt_pk_bf16_f32 v81, v81, v121
  v_cvt_pk_bf16_f32 v82, v82, v122
  v_cvt_pk_bf16_f32 v83, v83, v123
  v_cvt_pk_bf16_f32 v84, v84, v124
  v_cvt_pk_bf16_f32 v85, v85, v125
  v_cvt_pk_bf16_f32 v86, v86, v126
  v_cvt_pk_bf16_f32 v87, v87, v127
  s_waitcnt vmcnt(0)
  s_mov_b32 s58, 4000
L_ln_non:
  v_readfirstlane_b32 s59, v150
  s_nop 3
  s_cmp_lg_u32 s59, 0
  s_cbranch_scc1 L_ln_non_ok
  s_sub_u32 s58, s58, 1
  s_cmp_eq_u32 s58, 0
  s_cbranch_scc1 L_ln_non_ok
  s_sleep 4
  v_mov_b32 v151, 0
  buffer_load_dword v150, v151, s[28:31], 0 offen sc1
  s_waitcnt vmcnt(0)
  s_branch L_ln_non
L_ln_non_ok:
  s_lshr_b32 s38, s61, 2
  s_lshl_b32 s38, s38, 7
  s_and_b32 s39, s61, 3
  s_lshl_b32 s39, s39, 2
  s_add_u32 s39, s39, s32
  s_lshl_b32 s39, s39, 2
  s_add_u32 s38, s38, s39
  s_add_u32 s38, s38, 0
  v_mov_b32 v136, s38
  v_mov_b32 v137, s59
  s_mov_b64 exec, 1
  buffer_store_dword v137, v136, s[4:7], 0 offen sc1
  s_mov_b64 exec, -1
  ds_write_b32 v144, v48 offset:0
  ds_write_b32 v144, v49 offset:64
  ds_write_b32 v144, v50 offset:128
  ds_write_b32 v144, v51 offset:192
  ds_write_b32 v144, v52 offset:256
  ds_write_b32 v144, v53 offset:320
  ds_write_b32 v144, v54 offset:384
  ds_write_b32 v144, v55 offset:448
  ds_write_b32 v144, v56 offset:8320
  ds_write_b32 v144, v57 offset:8384
  ds_write_b32 v144, v58 offset:8448
  ds_write_b32 v144, v59 offset:8512
  ds_write_b32 v144, v60 offset:8576
  ds_write_b32 v144, v61 offset:8640
  ds_write_b32 v144, v62 offset:8704
  ds_write_b32 v144, v63 offset:8768
  ds_write_b32 v144, v64 offset:16640
  ds_write_b32 v144, v65 offset:16704
  ds_write_b32 v144, v66 offset:16768
  ds_write_b32 v144, v67 offset:16832
  ds_write_b32 v144, v68 offset:16896
  ds_write_b32 v144, v69 offset:16960
  ds_write_b32 v144, v70 offset:17024
  ds_write_b32 v144, v71 offset:17088
  ds_write_b32 v144, v72 offset:24960
  ds_write_b32 v144, v73 offset:25024
  ds_write_b32 v144, v74 offset:25088
  ds_write_b32 v144, v75 offset:25152
  ds_write_b32 v144, v76 offset:25216
  ds_write_b32 v144, v77 offset:25280
  ds_write_b32 v144, v78 offset:25344
  ds_write_b32 v144, v79 offset:25408
  ds_write_b32 v144, v80 offset:33280
  ds_write_b32 v144, v81 offset:33344
  ds_write_b32 v144, v82 offset:33408
  ds_write_b32 v144, v83 offset:33472
  ds_write_b32 v144, v84 offset:33536
  ds_write_b32 v144, v85 offset:33600
  ds_write_b32 v144, v86 offset:33664
  ds_write_b32 v144, v87 offset:33728
  s_waitcnt lgkmcnt(0)
  s_barrier
  v_lshrrev_b32 v136, 2, v2
  v_and_b32 v137, 3, v2
  s_mul_i32 s38, s32, 160
  v_add_u32 v136, s38, v136
  v_lshrrev_b32 v138, 3, v136
  v_lshlrev_b32 v138, 1, v138
  v_lshl_add_u32 v138, v136, 4, v138
  v_lshl_add_u32 v138, v137, 2, v138
  v_lshlrev_b32 v138, 2, v138
  v_lshlrev_b32 v139, 6, v136
  v_lshl_add_u32 v139, v137, 4, v139
  s_mul_i32 s39, s61, 40960
  ds_read_b64 v[48:49], v138 offset:0
  ds_read_b64 v[50:51], v138 offset:8
  ds_read_b64 v[52:53], v138 offset:1040
  ds_read_b64 v[54:55], v138 offset:1048
  ds_read_b64 v[56:57], v138 offset:2080
  ds_read_b64 v[58:59], v138 offset:2088
  ds_read_b64 v[60:61], v138 offset:3120
  ds_read_b64 v[62:63], v138 offset:3128
  ds_read_b64 v[64:65], v138 offset:4160
  ds_read_b64 v[66:67], v138 offset:4168
  ds_read_b64 v[68:69], v138 offset:5200
  ds_read_b64 v[70:71], v138 offset:5208
  ds_read_b64 v[72:73], v138 offset:6240
  ds_read_b64 v[74:75], v138 offset:6248
  ds_read_b64 v[76:77], v138 offset:7280
  ds_read_b64 v[78:79], v138 offset:7288
  ds_read_b64 v[80:81], v138 offset:8320
  ds_read_b64 v[82:83], v138 offset:8328
  ds_read_b64 v[84:85], v138 offset:9360
  ds_read_b64 v[86:87], v138 offset:9368
  s_waitcnt lgkmcnt(15)
  buffer_store_dwordx4 v[48:51], v139, s[12:15], s39 offen sc1
  s_waitcnt lgkmcnt(15)
  s_add_u32 s39, s39, 1024
  buffer_store_dwordx4 v[52:55], v139, s[12:15], s39 offen sc1
  s_waitcnt lgkmcnt(14)
  s_add_u32 s39, s39, 1024
  buffer_store_dwordx4 v[56:59], v139, s[12:15], s39 offen sc1
  s_waitcnt lgkmcnt(12)
  s_add_u32 s39, s39, 1024
  buffer_store_dwordx4 v[60:63], v139, s[12:15], s39 offen sc1
  s_waitcnt lgkmcnt(10)
  s_add_u32 s39, s39, 1024
  buffer_store_dwordx4 v[64:67], v139, s[12:15], s39 offen sc1
  s_waitcnt lgkmcnt(8)
  s_add_u32 s39, s39, 1024
  buffer_store_dwordx4 v[68:71], v139, s[12:15], s39 offen sc1
  s_waitcnt lgkmcnt(6)
  s_add_u32 s39, s39, 1024
  buffer_store_dwordx4 v[72:75], v139, s[12:15], s39 offen sc1
  s_waitcnt lgkmcnt(4)
  s_add_u32 s39, s39, 1024
  buffer_store_dwordx4 v[76:79], v139, s[12:15], s39 offen sc1
  s_waitcnt lgkmcnt(2)
  s_add_u32 s39, s39, 1024
  buffer_store_dwordx4 v[80:83], v139, s[12:15], s39 offen sc1
  s_waitcnt lgkmcnt(0)
  s_add_u32 s39, s39, 1024
  buffer_store_dwordx4 v[84:87], v139, s[12:15], s39 offen sc1
  s_waitcnt vmcnt(0)
  s_barrier
  s_cmp_lg_u32 s32, 0
  s_cbranch_scc1 L_ln_done
  s_lshl_b32 s38, s61, 2
  s_add_u32 s38, s38, 10240
  v_mov_b32 v136, s38
  v_mov_b32 v137, s59
  s_mov_b64 exec, 1
  buffer_store_dword v137, v136, s[4:7], 0 offen sc1
  s_mov_b64 exec, -1
L_ln_done:
  s_cmp_lt_u32 s2, 256
  s_cbranch_scc1 L_G_spare
  s_sub_u32 s33, s2, 480
  s_lshl_b32 s33, s33, 2
  s_add_u32 s33, s33, s32
  s_cmp_gt_u32 s33, 4
  s_cbranch_scc1 L_agg_end
  s_setprio 3
  s_add_u32 s33, s33, 1
  s_cmp_eq_u32 s33, 5
  s_cselect_b32 s33, 0, s33
  s_sub_u32 s34, s33, 1
  s_lshl_b32 s34, s34, 8
  s_add_u32 s34, s34, 8192
  s_cmp_eq_u32 s33, 0
  s_cselect_b32 s34, 10240, s34
  s_cselect_b32 s35, 63, 53
  v_min_u32 v32, s35, v2
  v_lshlrev_b32 v32, 2, v32
  v_add_u32 v32, s34, v32
  buffer_load_dword v33, v32, s[4:7], 0 offen sc1
  s_waitcnt vmcnt(0)
  s_mov_b32 s58, 4000
L_agg:
  v_cmp_eq_u32 vcc, s59, v33
  s_nop 3
  s_cmp_eq_u64 vcc, -1
  s_cbranch_scc1 L_agg_ok
  s_sub_u32 s58, s58, 1
  s_cmp_eq_u32 s58, 0
  s_cbranch_scc1 L_agg_ok
  s_sleep 4
  buffer_load_dword v33, v32, s[4:7], 0 offen sc1
  s_waitcnt vmcnt(0)
  s_branch L_agg
L_agg_ok:
  s_lshl_b32 s34, s33, 2
  s_add_u32 s34, s34, 12288
  v_mul_u32_u24 v34, 128, v2
  v_add_u32 v34, s34, v34
  v_mov_b32 v35, s59
  s_mov_b64 exec, 255
  buffer_store_dword v35, v34, s[4:7], 0 offen sc1
  s_mov_b64 exec, -1
L_agg_end:
  s_waitcnt vmcnt(0)
  s_endpgm
L_G_spare:
  s_setprio 0
L_G2pre:
  s_waitcnt lgkmcnt(0)
  s_mov_b32 s57, -1
  s_add_u32 s4, s92, 20185088
  s_addc_u32 s5, s93, 0
  s_mov_b32 s6, 16384
  s_mov_b32 s7, 0x00020000
  s_and_b32 s46, s2, 1
  s_lshl_b32 s46, s46, 1
  s_lshr_b32 s47, s2, 7
  s_add_u32 s46, s46, s47
  s_lshl_b32 s46, s46, 2
  s_and_b32 s47, s2, 7
  s_lshl_b32 s47, s47, 7
  s_add_u32 s46, s46, s47
  s_add_u32 s46, s46, 12292
  s_cmp_eq_u32 s32, 0
  s_cselect_b32 s46, s46, 0x7f000000
  v_mov_b32 v146, s46
  buffer_load_dword v147, v146, s[4:7], 0 offen sc1
  s_waitcnt vmcnt(0)
  s_cmp_lg_u32 s32, 0
  s_cbranch_scc1 L_G2pre_ok
  s_mov_b32 s58, 4000
L_G2pre_w:
  v_cmp_eq_u32 vcc, s59, v147
  s_nop 3
  s_cmp_eq_u64 vcc, -1
  s_cbranch_scc1 L_G2pre_w_ok
  s_sub_u32 s58, s58, 1
  s_cmp_eq_u32 s58, 0
  s_cbranch_scc1 L_G2pre_w_ok
  s_sleep 8
  buffer_load_dword v147, v146, s[4:7], 0 offen sc1
  s_waitcnt vmcnt(0)
  s_branch L_G2pre_w
L_G2pre_w_ok:
L_G2pre_ok:
  s_barrier
L_G2:
  s_and_b32 s35, s2, 7
  s_lshr_b32 s36, s2, 3
  s_lshr_b32 s33, s35, 1
  s_lshl_b32 s33, s33, 3
  s_and_b32 s37, s36, 7
  s_add_u32 s33, s33, s37
  s_and_b32 s34, s35, 1
  s_lshl_b32 s34, s34, 2
  s_lshr_b32 s37, s36, 3
  s_add_u32 s34, s34, s37
  s_mul_i32 s35, s32, 14
  s_cmp_eq_u32 s32, 3
  s_cselect_b32 s36, 1, 0
  s_sub_u32 s35, s35, s36
  s_mul_i32 s40, s33, 54
  s_add_u32 s40, s40, s35
  s_lshl_b32 s40, s40, 12
  s_mul_i32 s41, s34, 54
  s_add_u32 s41, s41, s35
  s_mul_i32 s41, s41, 5120
  s_cmp_lt_u32 s32, 2
  s_cselect_b32 s63, 14, 13
  s_and_b32 s37, s34, 3
  s_lshl_b32 s37, s37, 2
  s_and_b32 s36, s33, 7
  s_lshl_b32 s36, s36, 1
  s_add_u32 s37, s37, s36
  s_cmp_ge_u32 s37, s63
  s_cselect_b32 s36, s63, 0
  s_sub_u32 s37, s37, s36
  s_cmp_ge_u32 s37, s63
  s_cselect_b32 s36, s63, 0
  s_sub_u32 s37, s37, s36
  s_sub_u32 s62, s63, s37
  s_lshl_b32 s36, s37, 12
  s_add_u32 s40, s40, s36
  s_lshl_b32 s36, s63, 12
  s_sub_u32 s60, s40, s36
  s_mul_i32 s36, s37, 5120
  s_add_u32 s41, s41, s36
  s_mul_i32 s36, s63, 5120
  s_sub_u32 s61, s41, s36
  s_cmp_le_u32 s62, 13
  s_cselect_b32 s42, s60, s40
  s_cselect_b32 s43, s61, s41
  s_add_u32 s42, s42, 53248
  s_add_u32 s43, s43, 66560
  s_cmp_lt_u32 s32, 2
  s_cselect_b32 s42, s42, 0x7f000000
  s_cselect_b32 s43, s43, 0x7f000000
  v_lshlrev_b32 v3, 4, v2
  v_add_u32 v4, 4096, v3
  s_waitcnt lgkmcnt(0)
  s_mov_b32 s8, s92
  s_mov_b32 s9, s93
  s_mov_b32 s10, 7077888
  s_mov_b32 s11, 0x00020000
  s_add_u32 s12, s92, 16777216
  s_addc_u32 s13, s93, 0
  s_mov_b32 s14, 2211840
  s_mov_b32 s15, 0x00020000
  s_mov_b32 s28, s90
  s_mov_b32 s29, s91
  s_mov_b32 s30, 256
  s_mov_b32 s31, 0x00020000
  s_add_u32 s4, s92, 20185088
  s_addc_u32 s5, s93, 0
  s_mov_b32 s6, 16384
  s_mov_b32 s7, 0x00020000
  s_add_u32 s20, s92, 10485760
  s_addc_u32 s21, s93, 0
  s_mov_b32 s22, 2621440
  s_mov_b32 s23, 0x00020000
  s_mov_b32 s16, s64
  s_mov_b32 s17, s65
  s_mov_b32 s18, 2621440
  s_mov_b32 s19, 0x00020000
  s_mov_b32 s24, s88
  s_mov_b32 s25, s89
  s_mov_b32 s26, 2621440
  s_mov_b32 s27, 0x00020000
  s_mov_b32 s44, s86
  s_mov_b32 s45, s87
  s_mov_b32 s46, 1280
  s_mov_b32 s47, 0x00020000
  s_cmp_eq_u32 s57, -1
  s_cbranch_scc1 L_g2_fast
  s_cmp_lg_u32 s32, 0
  s_cbranch_scc1 L_g2_v1
  s_waitcnt vmcnt(4)
  v_cmp_eq_u32 vcc, s59, v147
  s_nop 3
  s_cmp_eq_u64 vcc, -1
  s_cselect_b32 s37, 1, 0
  v_mov_b32 v5, s37
  v_mov_b32 v6, 2048
  ds_write_b32 v6, v5
  s_waitcnt lgkmcnt(0)
L_g2_v1:
  s_barrier
  v_mov_b32 v6, 2048
  ds_read_b32 v5, v6
  s_waitcnt lgkmcnt(0)
  v_readfirstlane_b32 s37, v5
  s_nop 3
  s_cmp_eq_u32 s37, 1
  s_cbranch_scc1 L_g2_fast
  s_waitcnt vmcnt(0)
  s_barrier
  s_cmp_lg_u32 s32, 0
  s_cbranch_scc1 L_g2_slow2
  v_mov_b32 v5, s57
  v_mov_b32 v6, s59
  s_mov_b64 exec, 1
  buffer_store_dword v6, v5, s[4:7], 0 offen sc1
  s_mov_b64 exec, -1
  s_mov_b32 s58, 4000
L_g2_w2f:
  v_cmp_eq_u32 vcc, s59, v147
  s_nop 3
  s_cmp_eq_u64 vcc, -1
  s_cbranch_scc1 L_g2_w2f_ok
  s_sub_u32 s58, s58, 1
  s_cmp_eq_u32 s58, 0
  s_cbranch_scc1 L_g2_w2f_ok
  s_sleep 8
  buffer_load_dword v147, v146, s[4:7], 0 offen sc1
  s_waitcnt vmcnt(0)
  s_branch L_g2_w2f
L_g2_w2f_ok:
L_g2_slow2:
  s_mov_b32 s57, -1
  s_barrier
L_g2_fast:
  s_cmp_le_u32 s62, 0
  s_cselect_b32 s39, s61, s41
  s_add_u32 s39, s39, 0
  buffer_load_dwordx4 v[88:91], v3, s[12:15], s39 offen offset:0 sc1
  buffer_load_dwordx4 v[92:95], v3, s[12:15], s39 offen offset:1024 sc1
  buffer_load_dwordx4 v[96:99], v3, s[12:15], s39 offen offset:2048 sc1
  buffer_load_dwordx4 v[100:103], v3, s[12:15], s39 offen offset:3072 sc1
  buffer_load_dwordx4 v[104:107], v4, s[12:15], s39 offen sc1
  s_cmp_le_u32 s62, 1
  s_cselect_b32 s51, s61, s41
  s_add_u32 s51, s51, 5120
  buffer_load_dwordx4 v[124:127], v3, s[12:15], s51 offen offset:0 sc1
  buffer_load_dwordx4 v[128:131], v3, s[12:15], s51 offen offset:1024 sc1
  buffer_load_dwordx4 v[132:135], v3, s[12:15], s51 offen offset:2048 sc1
  buffer_load_dwordx4 v[136:139], v3, s[12:15], s51 offen offset:3072 sc1
  buffer_load_dwordx4 v[140:143], v4, s[12:15], s51 offen sc1
  s_cmp_le_u32 s62, 2
  s_cselect_b32 s39, s61, s41
  s_add_u32 s39, s39, 10240
  buffer_load_dwordx4 v[160:163], v3, s[12:15], s39 offen offset:0 sc1
  buffer_load_dwordx4 v[164:167], v3, s[12:15], s39 offen offset:1024 sc1
  buffer_load_dwordx4 v[168:171], v3, s[12:15], s39 offen offset:2048 sc1
  buffer_load_dwordx4 v[172:175], v3, s[12:15], s39 offen offset:3072 sc1
  buffer_load_dwordx4 v[176:179], v4, s[12:15], s39 offen sc1
  s_waitcnt vmcnt(15)
  s_barrier
  s_cmp_lg_u32 s32, 0
  s_cbranch_scc1 L_g2_h_ok2
  s_cmp_eq_u32 s57, -1
  s_cbranch_scc1 L_g2_nosig
  v_mov_b32 v5, s57
  v_mov_b32 v6, s59
  s_mov_b64 exec, 1
  buffer_store_dword v6, v5, s[4:7], 0 offen sc1
  s_mov_b64 exec, -1
L_g2_nosig:
  s_lshr_b32 s37, s33, 1
  s_lshl_b32 s37, s37, 7
  s_add_u32 s37, s37, 4608
  v_min_u32 v6, 13, v2
  v_lshlrev_b32 v6, 2, v6
  v_add_u32 v6, s37, v6
  buffer_load_dword v5, v6, s[4:7], 0 offen sc1
  s_waitcnt vmcnt(0)
  s_mov_b32 s58, 4000
L_g2_h:
  v_cmp_eq_u32 vcc, s59, v5
  s_nop 3
  s_cmp_eq_u64 vcc, -1
  s_cbranch_scc1 L_g2_h_ok
  s_sub_u32 s58, s58, 1
  s_cmp_eq_u32 s58, 0
  s_cbranch_scc1 L_g2_h_ok
  s_sleep 4
  buffer_load_dword v5, v6, s[4:7], 0 offen sc1
  s_waitcnt vmcnt(0)
  s_branch L_g2_h
L_g2_h_ok:
L_g2_h_ok2:
  s_barrier
  s_cmp_le_u32 s62, 0
  s_cselect_b32 s38, s60, s40
  s_add_u32 s38, s38, 0
  buffer_load_dwordx4 v[108:111], v3, s[8:11], s38 offen offset:0 sc1
  buffer_load_dwordx4 v[112:115], v3, s[8:11], s38 offen offset:1024 sc1
  buffer_load_dwordx4 v[116:119], v3, s[8:11], s38 offen offset:2048 sc1
  buffer_load_dwordx4 v[120:123], v3, s[8:11], s38 offen offset:3072 sc1
  s_cmp_le_u32 s62, 1
  s_cselect_b32 s50, s60, s40
  s_add_u32 s50, s50, 4096
  buffer_load_dwordx4 v[144:147], v3, s[8:11], s50 offen offset:0 sc1
  buffer_load_dwordx4 v[148:151], v3, s[8:11], s50 offen offset:1024 sc1
  buffer_load_dwordx4 v[152:155], v3, s[8:11], s50 offen offset:2048 sc1
  buffer_load_dwordx4 v[156:159], v3, s[8:11], s50 offen offset:3072 sc1
  s_cmp_le_u32 s62, 2
  s_cselect_b32 s38, s60, s40
  s_add_u32 s38, s38, 8192
  buffer_load_dwordx4 v[180:183], v3, s[8:11], s38 offen offset:0 sc1
  buffer_load_dwordx4 v[184:187], v3, s[8:11], s38 offen offset:1024 sc1
  buffer_load_dwordx4 v[188:191], v3, s[8:11], s38 offen offset:2048 sc1
  buffer_load_dwordx4 v[192:195], v3, s[8:11], s38 offen offset:3072 sc1
  s_lshl_b32 s56, s34, 7
  s_add_u32 s56, s56, 6656
  s_cmp_eq_u32 s32, 0
  s_cselect_b32 s56, s56, 0x7f000000
  v_min_u32 v6, 27, v2
  v_lshlrev_b32 v6, 2, v6
  v_add_u32 v6, s56, v6
  s_waitcnt vmcnt(8)
  v_mfma_f32_16x16x32_bf16 v[8:11], v[88:91], v[108:111], 0
  s_cmp_le_u32 s62, 3
  s_cselect_b32 s50, s60, s40
  s_add_u32 s50, s50, 12288
  v_mfma_f32_16x16x32_bf16 v[12:15], v[88:91], v[112:115], 0
  v_mfma_f32_16x16x32_bf16 v[16:19], v[88:91], v[116:119], 0
  buffer_load_dwordx4 v[216:219], v3, s[8:11], s50 offen offset:0 sc1
  v_mfma_f32_16x16x32_bf16 v[20:23], v[88:91], v[120:123], 0
  v_mfma_f32_16x16x32_bf16 v[24:27], v[92:95], v[108:111], 0
  buffer_load_dwordx4 v[220:223], v3, s[8:11], s50 offen offset:1024 sc1
  v_mfma_f32_16x16x32_bf16 v[28:31], v[92:95], v[112:115], 0
  v_mfma_f32_16x16x32_bf16 v[32:35], v[92:95], v[116:119], 0
  buffer_load_dwordx4 v[224:227], v3, s[8:11], s50 offen offset:2048 sc1
  v_mfma_f32_16x16x32_bf16 v[36:39], v[92:95], v[120:123], 0
  v_mfma_f32_16x16x32_bf16 v[40:43], v[96:99], v[108:111], 0
  buffer_load_dwordx4 v[228:231], v3, s[8:11], s50 offen offset:3072 sc1
  s_cmp_le_u32 s62, 3
  s_cselect_b32 s51, s61, s41
  v_mfma_f32_16x16x32_bf16 v[44:47], v[96:99], v[112:115], 0
  s_add_u32 s51, s51, 15360
  v_mfma_f32_16x16x32_bf16 v[48:51], v[96:99], v[116:119], 0
  buffer_load_dwordx4 v[196:199], v3, s[12:15], s51 offen offset:0 sc1
  v_mfma_f32_16x16x32_bf16 v[52:55], v[96:99], v[120:123], 0
  v_mfma_f32_16x16x32_bf16 v[56:59], v[100:103], v[108:111], 0
  buffer_load_dwordx4 v[200:203], v3, s[12:15], s51 offen offset:1024 sc1
  v_mfma_f32_16x16x32_bf16 v[60:63], v[100:103], v[112:115], 0
  v_mfma_f32_16x16x32_bf16 v[64:67], v[100:103], v[116:119], 0
  buffer_load_dwordx4 v[204:207], v3, s[12:15], s51 offen offset:2048 sc1
  v_mfma_f32_16x16x32_bf16 v[68:71], v[100:103], v[120:123], 0
  v_mfma_f32_16x16x32_bf16 v[72:75], v[104:107], v[108:111], 0
  buffer_load_dwordx4 v[208:211], v3, s[12:15], s51 offen offset:3072 sc1
  v_mfma_f32_16x16x32_bf16 v[76:79], v[104:107], v[112:115], 0
  v_mfma_f32_16x16x32_bf16 v[80:83], v[104:107], v[116:119], 0
  buffer_load_dwordx4 v[212:215], v4, s[12:15], s51 offen sc1
  v_mfma_f32_16x16x32_bf16 v[84:87], v[104:107], v[120:123], 0
  s_waitcnt vmcnt(13)
  v_mfma_f32_16x16x32_bf16 v[8:11], v[124:127], v[144:147], v[8:11]
  s_cmp_le_u32 s62, 4
  s_cselect_b32 s38, s60, s40
  s_add_u32 s38, s38, 16384
  v_mfma_f32_16x16x32_bf16 v[12:15], v[124:127], v[148:151], v[12:15]
  v_mfma_f32_16x16x32_bf16 v[16:19], v[124:127], v[152:155], v[16:19]
  buffer_load_dwordx4 v[108:111], v3, s[8:11], s38 offen offset:0 sc1
  v_mfma_f32_16x16x32_bf16 v[20:23], v[124:127], v[156:159], v[20:23]
  v_mfma_f32_16x16x32_bf16 v[24:27], v[128:131], v[144:147], v[24:27]
  buffer_load_dwordx4 v[112:115], v3, s[8:11], s38 offen offset:1024 sc1
  v_mfma_f32_16x16x32_bf16 v[28:31], v[128:131], v[148:151], v[28:31]
  v_mfma_f32_16x16x32_bf16 v[32:35], v[128:131], v[152:155], v[32:35]
  buffer_load_dwordx4 v[116:119], v3, s[8:11], s38 offen offset:2048 sc1
  v_mfma_f32_16x16x32_bf16 v[36:39], v[128:131], v[156:159], v[36:39]
  v_mfma_f32_16x16x32_bf16 v[40:43], v[132:135], v[144:147], v[40:43]
  buffer_load_dwordx4 v[120:123], v3, s[8:11], s38 offen offset:3072 sc1
  s_cmp_le_u32 s62, 4
  s_cselect_b32 s39, s61, s41
  v_mfma_f32_16x16x32_bf16 v[44:47], v[132:135], v[148:151], v[44:47]
  s_add_u32 s39, s39, 20480
  v_mfma_f32_16x16x32_bf16 v[48:51], v[132:135], v[152:155], v[48:51]
  buffer_load_dwordx4 v[88:91], v3, s[12:15], s39 offen offset:0 sc1
  v_mfma_f32_16x16x32_bf16 v[52:55], v[132:135], v[156:159], v[52:55]
  v_mfma_f32_16x16x32_bf16 v[56:59], v[136:139], v[144:147], v[56:59]
  buffer_load_dwordx4 v[92:95], v3, s[12:15], s39 offen offset:1024 sc1
  v_mfma_f32_16x16x32_bf16 v[60:63], v[136:139], v[148:151], v[60:63]
  v_mfma_f32_16x16x32_bf16 v[64:67], v[136:139], v[152:155], v[64:67]
  buffer_load_dwordx4 v[96:99], v3, s[12:15], s39 offen offset:2048 sc1
  v_mfma_f32_16x16x32_bf16 v[68:71], v[136:139], v[156:159], v[68:71]
  v_mfma_f32_16x16x32_bf16 v[72:75], v[140:143], v[144:147], v[72:75]
  buffer_load_dwordx4 v[100:103], v3, s[12:15], s39 offen offset:3072 sc1
  v_mfma_f32_16x16x32_bf16 v[76:79], v[140:143], v[148:151], v[76:79]
  v_mfma_f32_16x16x32_bf16 v[80:83], v[140:143], v[152:155], v[80:83]
  buffer_load_dwordx4 v[104:107], v4, s[12:15], s39 offen sc1
  v_mfma_f32_16x16x32_bf16 v[84:87], v[140:143], v[156:159], v[84:87]
  s_waitcnt vmcnt(18)
  v_mfma_f32_16x16x32_bf16 v[8:11], v[160:163], v[180:183], v[8:11]
  s_cmp_le_u32 s62, 5
  s_cselect_b32 s50, s60, s40
  s_add_u32 s50, s50, 20480
  v_mfma_f32_16x16x32_bf16 v[12:15], v[160:163], v[184:187], v[12:15]
  v_mfma_f32_16x16x32_bf16 v[16:19], v[160:163], v[188:191], v[16:19]
  buffer_load_dwordx4 v[144:147], v3, s[8:11], s50 offen offset:0 sc1
  v_mfma_f32_16x16x32_bf16 v[20:23], v[160:163], v[192:195], v[20:23]
  v_mfma_f32_16x16x32_bf16 v[24:27], v[164:167], v[180:183], v[24:27]
  buffer_load_dwordx4 v[148:151], v3, s[8:11], s50 offen offset:1024 sc1
  v_mfma_f32_16x16x32_bf16 v[28:31], v[164:167], v[184:187], v[28:31]
  v_mfma_f32_16x16x32_bf16 v[32:35], v[164:167], v[188:191], v[32:35]
  buffer_load_dwordx4 v[152:155], v3, s[8:11], s50 offen offset:2048 sc1
  v_mfma_f32_16x16x32_bf16 v[36:39], v[164:167], v[192:195], v[36:39]
  v_mfma_f32_16x16x32_bf16 v[40:43], v[168:171], v[180:183], v[40:43]
  buffer_load_dwordx4 v[156:159], v3, s[8:11], s50 offen offset:3072 sc1
  s_cmp_le_u32 s62, 5
  s_cselect_b32 s51, s61, s41
  v_mfma_f32_16x16x32_bf16 v[44:47], v[168:171], v[184:187], v[44:47]
  s_add_u32 s51, s51, 25600
  v_mfma_f32_16x16x32_bf16 v[48:51], v[168:171], v[188:191], v[48:51]
  buffer_load_dwordx4 v[124:127], v3, s[12:15], s51 offen offset:0 sc1
  v_mfma_f32_16x16x32_bf16 v[52:55], v[168:171], v[192:195], v[52:55]
  v_mfma_f32_16x16x32_bf16 v[56:59], v[172:175], v[180:183], v[56:59]
  buffer_load_dwordx4 v[128:131], v3, s[12:15], s51 offen offset:1024 sc1
  v_mfma_f32_16x16x32_bf16 v[60:63], v[172:175], v[184:187], v[60:63]
  v_mfma_f32_16x16x32_bf16 v[64:67], v[172:175], v[188:191], v[64:67]
  buffer_load_dwordx4 v[132:135], v3, s[12:15], s51 offen offset:2048 sc1
  v_mfma_f32_16x16x32_bf16 v[68:71], v[172:175], v[192:195], v[68:71]
  v_mfma_f32_16x16x32_bf16 v[72:75], v[176:179], v[180:183], v[72:75]
  buffer_load_dwordx4 v[136:139], v3, s[12:15], s51 offen offset:3072 sc1
  v_mfma_f32_16x16x32_bf16 v[76:79], v[176:179], v[184:187], v[76:79]
  v_mfma_f32_16x16x32_bf16 v[80:83], v[176:179], v[188:191], v[80:83]
  buffer_load_dwordx4 v[140:143], v4, s[12:15], s51 offen sc1
  v_mfma_f32_16x16x32_bf16 v[84:87], v[176:179], v[192:195], v[84:87]
  s_waitcnt vmcnt(18)
  v_mfma_f32_16x16x32_bf16 v[8:11], v[196:199], v[216:219], v[8:11]
  s_cmp_le_u32 s62, 6
  s_cselect_b32 s38, s60, s40
  s_add_u32 s38, s38, 24576
  v_mfma_f32_16x16x32_bf16 v[12:15], v[196:199], v[220:223], v[12:15]
  v_mfma_f32_16x16x32_bf16 v[16:19], v[196:199], v[224:227], v[16:19]
  buffer_load_dwordx4 v[180:183], v3, s[8:11], s38 offen offset:0 sc1
  v_mfma_f32_16x16x32_bf16 v[20:23], v[196:199], v[228:231], v[20:23]
  v_mfma_f32_16x16x32_bf16 v[24:27], v[200:203], v[216:219], v[24:27]
  buffer_load_dwordx4 v[184:187], v3, s[8:11], s38 offen offset:1024 sc1
  v_mfma_f32_16x16x32_bf16 v[28:31], v[200:203], v[220:223], v[28:31]
  v_mfma_f32_16x16x32_bf16 v[32:35], v[200:203], v[224:227], v[32:35]
  buffer_load_dwordx4 v[188:191], v3, s[8:11], s38 offen offset:2048 sc1
  v_mfma_f32_16x16x32_bf16 v[36:39], v[200:203], v[228:231], v[36:39]
  v_mfma_f32_16x16x32_bf16 v[40:43], v[204:207], v[216:219], v[40:43]
  buffer_load_dwordx4 v[192:195], v3, s[8:11], s38 offen offset:3072 sc1
  s_cmp_le_u32 s62, 6
  s_cselect_b32 s39, s61, s41
  v_mfma_f32_16x16x32_bf16 v[44:47], v[204:207], v[220:223], v[44:47]
  s_add_u32 s39, s39, 30720
  v_mfma_f32_16x16x32_bf16 v[48:51], v[204:207], v[224:227], v[48:51]
  buffer_load_dwordx4 v[160:163], v3, s[12:15], s39 offen offset:0 sc1
  v_mfma_f32_16x16x32_bf16 v[52:55], v[204:207], v[228:231], v[52:55]
  v_mfma_f32_16x16x32_bf16 v[56:59], v[208:211], v[216:219], v[56:59]
  buffer_load_dwordx4 v[164:167], v3, s[12:15], s39 offen offset:1024 sc1
  v_mfma_f32_16x16x32_bf16 v[60:63], v[208:211], v[220:223], v[60:63]
  v_mfma_f32_16x16x32_bf16 v[64:67], v[208:211], v[224:227], v[64:67]
  buffer_load_dwordx4 v[168:171], v3, s[12:15], s39 offen offset:2048 sc1
  v_mfma_f32_16x16x32_bf16 v[68:71], v[208:211], v[228:231], v[68:71]
  v_mfma_f32_16x16x32_bf16 v[72:75], v[212:215], v[216:219], v[72:75]
  buffer_load_dwordx4 v[172:175], v3, s[12:15], s39 offen offset:3072 sc1
  v_mfma_f32_16x16x32_bf16 v[76:79], v[212:215], v[220:223], v[76:79]
  v_mfma_f32_16x16x32_bf16 v[80:83], v[212:215], v[224:227], v[80:83]
  buffer_load_dwordx4 v[176:179], v4, s[12:15], s39 offen sc1
  v_and_b32 v243, 15, v2
  v_lshrrev_b32 v244, 4, v2
  v_mfma_f32_16x16x32_bf16 v[84:87], v[212:215], v[228:231], v[84:87]
  v_mul_u32_u24 v238, 336, v243
  v_lshl_add_u32 v238, v244, 4, v238
  s_mov_b32 s54, 0x199a
  v_add_u32 v245, 0, v2
  v_mul_u32_u24 v246, s54, v245
  v_lshrrev_b32 v246, 16, v246
  v_mul_u32_u24 v235, 10, v246
  v_sub_u32 v245, v245, v235
  v_lshlrev_b32 v245, 4, v245
  s_waitcnt vmcnt(18)
  v_mfma_f32_16x16x32_bf16 v[8:11], v[88:91], v[108:111], v[8:11]
  s_cmp_le_u32 s62, 7
  s_cselect_b32 s50, s60, s40
  s_add_u32 s50, s50, 28672
  v_mfma_f32_16x16x32_bf16 v[12:15], v[88:91], v[112:115], v[12:15]
  v_mfma_f32_16x16x32_bf16 v[16:19], v[88:91], v[116:119], v[16:19]
  buffer_load_dwordx4 v[216:219], v3, s[8:11], s50 offen offset:0 sc1
  v_mfma_f32_16x16x32_bf16 v[20:23], v[88:91], v[120:123], v[20:23]
  v_mfma_f32_16x16x32_bf16 v[24:27], v[92:95], v[108:111], v[24:27]
  buffer_load_dwordx4 v[220:223], v3, s[8:11], s50 offen offset:1024 sc1
  v_mfma_f32_16x16x32_bf16 v[28:31], v[92:95], v[112:115], v[28:31]
  v_mfma_f32_16x16x32_bf16 v[32:35], v[92:95], v[116:119], v[32:35]
  buffer_load_dwordx4 v[224:227], v3, s[8:11], s50 offen offset:2048 sc1
  v_mfma_f32_16x16x32_bf16 v[36:39], v[92:95], v[120:123], v[36:39]
  v_mfma_f32_16x16x32_bf16 v[40:43], v[96:99], v[108:111], v[40:43]
  buffer_load_dwordx4 v[228:231], v3, s[8:11], s50 offen offset:3072 sc1
  s_cmp_le_u32 s62, 7
  s_cselect_b32 s51, s61, s41
  v_mfma_f32_16x16x32_bf16 v[44:47], v[96:99], v[112:115], v[44:47]
  s_add_u32 s51, s51, 35840
  v_mfma_f32_16x16x32_bf16 v[48:51], v[96:99], v[116:119], v[48:51]
  buffer_load_dwordx4 v[196:199], v3, s[12:15], s51 offen offset:0 sc1
  v_mfma_f32_16x16x32_bf16 v[52:55], v[96:99], v[120:123], v[52:55]
  v_mfma_f32_16x16x32_bf16 v[56:59], v[100:103], v[108:111], v[56:59]
  buffer_load_dwordx4 v[200:203], v3, s[12:15], s51 offen offset:1024 sc1
  v_mfma_f32_16x16x32_bf16 v[60:63], v[100:103], v[112:115], v[60:63]
  v_mfma_f32_16x16x32_bf16 v[64:67], v[100:103], v[116:119], v[64:67]
  buffer_load_dwordx4 v[204:207], v3, s[12:15], s51 offen offset:2048 sc1
  v_mfma_f32_16x16x32_bf16 v[68:71], v[100:103], v[120:123], v[68:71]
  v_mfma_f32_16x16x32_bf16 v[72:75], v[104:107], v[108:111], v[72:75]
  buffer_load_dwordx4 v[208:211], v3, s[12:15], s51 offen offset:3072 sc1
  v_mfma_f32_16x16x32_bf16 v[76:79], v[104:107], v[112:115], v[76:79]
  v_mfma_f32_16x16x32_bf16 v[80:83], v[104:107], v[116:119], v[80:83]
  buffer_load_dwordx4 v[212:215], v4, s[12:15], s51 offen sc1
  v_mul_u32_u24 v232, 1280, v246
  v_add_u32 v232, v232, v245
  v_mfma_f32_16x16x32_bf16 v[84:87], v[104:107], v[120:123], v[84:87]
  v_mul_u32_u24 v235, 176, v246
  v_add_u32 v235, v235, v245
  v_add_u32 v245, 64, v2
  v_mul_u32_u24 v246, s54, v245
  v_lshrrev_b32 v246, 16, v246
  v_mul_u32_u24 v236, 10, v246
  v_sub_u32 v245, v245, v236
  v_lshlrev_b32 v245, 4, v245
  s_waitcnt vmcnt(18)
  v_mfma_f32_16x16x32_bf16 v[8:11], v[124:127], v[144:147], v[8:11]
  s_cmp_le_u32 s62, 8
  s_cselect_b32 s38, s60, s40
  s_add_u32 s38, s38, 32768
  v_mfma_f32_16x16x32_bf16 v[12:15], v[124:127], v[148:151], v[12:15]
  v_mfma_f32_16x16x32_bf16 v[16:19], v[124:127], v[152:155], v[16:19]
  buffer_load_dwordx4 v[108:111], v3, s[8:11], s38 offen offset:0 sc1
  v_mfma_f32_16x16x32_bf16 v[20:23], v[124:127], v[156:159], v[20:23]
  v_mfma_f32_16x16x32_bf16 v[24:27], v[128:131], v[144:147], v[24:27]
  buffer_load_dwordx4 v[112:115], v3, s[8:11], s38 offen offset:1024 sc1
  v_mfma_f32_16x16x32_bf16 v[28:31], v[128:131], v[148:151], v[28:31]
  v_mfma_f32_16x16x32_bf16 v[32:35], v[128:131], v[152:155], v[32:35]
  buffer_load_dwordx4 v[116:119], v3, s[8:11], s38 offen offset:2048 sc1
  v_mfma_f32_16x16x32_bf16 v[36:39], v[128:131], v[156:159], v[36:39]
  v_mfma_f32_16x16x32_bf16 v[40:43], v[132:135], v[144:147], v[40:43]
  buffer_load_dwordx4 v[120:123], v3, s[8:11], s38 offen offset:3072 sc1
  s_cmp_le_u32 s62, 8
  s_cselect_b32 s39, s61, s41
  v_mfma_f32_16x16x32_bf16 v[44:47], v[132:135], v[148:151], v[44:47]
  s_add_u32 s39, s39, 40960
  v_mfma_f32_16x16x32_bf16 v[48:51], v[132:135], v[152:155], v[48:51]
  buffer_load_dwordx4 v[88:91], v3, s[12:15], s39 offen offset:0 sc1
  v_mfma_f32_16x16x32_bf16 v[52:55], v[132:135], v[156:159], v[52:55]
  v_mfma_f32_16x16x32_bf16 v[56:59], v[136:139], v[144:147], v[56:59]
  buffer_load_dwordx4 v[92:95], v3, s[12:15], s39 offen offset:1024 sc1
  v_mfma_f32_16x16x32_bf16 v[60:63], v[136:139], v[148:151], v[60:63]
  v_mfma_f32_16x16x32_bf16 v[64:67], v[136:139], v[152:155], v[64:67]
  buffer_load_dwordx4 v[96:99], v3, s[12:15], s39 offen offset:2048 sc1
  v_mfma_f32_16x16x32_bf16 v[68:71], v[136:139], v[156:159], v[68:71]
  v_mfma_f32_16x16x32_bf16 v[72:75], v[140:143], v[144:147], v[72:75]
  buffer_load_dwordx4 v[100:103], v3, s[12:15], s39 offen offset:3072 sc1
  v_mfma_f32_16x16x32_bf16 v[76:79], v[140:143], v[148:151], v[76:79]
  v_mfma_f32_16x16x32_bf16 v[80:83], v[140:143], v[152:155], v[80:83]
  buffer_load_dwordx4 v[104:107], v4, s[12:15], s39 offen sc1
  v_mul_u32_u24 v233, 1280, v246
  v_add_u32 v233, v233, v245
  v_mfma_f32_16x16x32_bf16 v[84:87], v[140:143], v[156:159], v[84:87]
  v_mul_u32_u24 v236, 176, v246
  v_add_u32 v236, v236, v245
  v_add_u32 v245, 128, v2
  v_mul_u32_u24 v246, s54, v245
  v_lshrrev_b32 v246, 16, v246
  v_mul_u32_u24 v237, 10, v246
  v_sub_u32 v245, v245, v237
  v_lshlrev_b32 v245, 4, v245
  s_waitcnt vmcnt(18)
  v_mfma_f32_16x16x32_bf16 v[8:11], v[160:163], v[180:183], v[8:11]
  s_cmp_le_u32 s62, 9
  s_cselect_b32 s50, s60, s40
  s_add_u32 s50, s50, 36864
  v_mfma_f32_16x16x32_bf16 v[12:15], v[160:163], v[184:187], v[12:15]
  v_mfma_f32_16x16x32_bf16 v[16:19], v[160:163], v[188:191], v[16:19]
  buffer_load_dwordx4 v[144:147], v3, s[8:11], s50 offen offset:0 sc1
  v_mfma_f32_16x16x32_bf16 v[20:23], v[160:163], v[192:195], v[20:23]
  v_mfma_f32_16x16x32_bf16 v[24:27], v[164:167], v[180:183], v[24:27]
  buffer_load_dwordx4 v[148:151], v3, s[8:11], s50 offen offset:1024 sc1
  v_mfma_f32_16x16x32_bf16 v[28:31], v[164:167], v[184:187], v[28:31]
  v_mfma_f32_16x16x32_bf16 v[32:35], v[164:167], v[188:191], v[32:35]
  buffer_load_dwordx4 v[152:155], v3, s[8:11], s50 offen offset:2048 sc1
  v_mfma_f32_16x16x32_bf16 v[36:39], v[164:167], v[192:195], v[36:39]
  v_mfma_f32_16x16x32_bf16 v[40:43], v[168:171], v[180:183], v[40:43]
  buffer_load_dwordx4 v[156:159], v3, s[8:11], s50 offen offset:3072 sc1
  s_cmp_le_u32 s62, 9
  s_cselect_b32 s51, s61, s41
  v_mfma_f32_16x16x32_bf16 v[44:47], v[168:171], v[184:187], v[44:47]
  s_add_u32 s51, s51, 46080
  v_mfma_f32_16x16x32_bf16 v[48:51], v[168:171], v[188:191], v[48:51]
  buffer_load_dwordx4 v[124:127], v3, s[12:15], s51 offen offset:0 sc1
  v_mfma_f32_16x16x32_bf16 v[52:55], v[168:171], v[192:195], v[52:55]
  v_mfma_f32_16x16x32_bf16 v[56:59], v[172:175], v[180:183], v[56:59]
  buffer_load_dwordx4 v[128:131], v3, s[12:15], s51 offen offset:1024 sc1
  v_mfma_f32_16x16x32_bf16 v[60:63], v[172:175], v[184:187], v[60:63]
  v_mfma_f32_16x16x32_bf16 v[64:67], v[172:175], v[188:191], v[64:67]
  buffer_load_dwordx4 v[132:135], v3, s[12:15], s51 offen offset:2048 sc1
  v_mfma_f32_16x16x32_bf16 v[68:71], v[172:175], v[192:195], v[68:71]
  v_mfma_f32_16x16x32_bf16 v[72:75], v[176:179], v[180:183], v[72:75]
  buffer_load_dwordx4 v[136:139], v3, s[12:15], s51 offen offset:3072 sc1
  v_mfma_f32_16x16x32_bf16 v[76:79], v[176:179], v[184:187], v[76:79]
  v_mfma_f32_16x16x32_bf16 v[80:83], v[176:179], v[188:191], v[80:83]
  buffer_load_dwordx4 v[140:143], v4, s[12:15], s51 offen sc1
  v_mul_u32_u24 v234, 1280, v246
  v_add_u32 v234, v234, v245
  v_mfma_f32_16x16x32_bf16 v[84:87], v[176:179], v[192:195], v[84:87]
  v_mul_u32_u24 v237, 176, v246
  v_add_u32 v237, v237, v245
  v_mov_b32 v245, 0x7f000000
  v_cmp_gt_u32 vcc, 32, v2
  s_nop 1
  v_cndmask_b32 v234, v245, v234, vcc
  v_cndmask_b32 v237, v236, v237, vcc
  s_lshl_b32 s52, s33, 6
  s_waitcnt vmcnt(18)
  v_mfma_f32_16x16x32_bf16 v[8:11], v[196:199], v[216:219], v[8:11]
  s_cmp_le_u32 s62, 10
  s_cselect_b32 s38, s60, s40
  s_add_u32 s38, s38, 40960
  v_mfma_f32_16x16x32_bf16 v[12:15], v[196:199], v[220:223], v[12:15]
  v_mfma_f32_16x16x32_bf16 v[16:19], v[196:199], v[224:227], v[16:19]
  buffer_load_dwordx4 v[180:183], v3, s[8:11], s38 offen offset:0 sc1
  v_mfma_f32_16x16x32_bf16 v[20:23], v[196:199], v[228:231], v[20:23]
  v_mfma_f32_16x16x32_bf16 v[24:27], v[200:203], v[216:219], v[24:27]
  buffer_load_dwordx4 v[184:187], v3, s[8:11], s38 offen offset:1024 sc1
  v_mfma_f32_16x16x32_bf16 v[28:31], v[200:203], v[220:223], v[28:31]
  v_mfma_f32_16x16x32_bf16 v[32:35], v[200:203], v[224:227], v[32:35]
  buffer_load_dwordx4 v[188:191], v3, s[8:11], s38 offen offset:2048 sc1
  v_mfma_f32_16x16x32_bf16 v[36:39], v[200:203], v[228:231], v[36:39]
  v_mfma_f32_16x16x32_bf16 v[40:43], v[204:207], v[216:219], v[40:43]
  buffer_load_dwordx4 v[192:195], v3, s[8:11], s38 offen offset:3072 sc1
  s_cmp_le_u32 s62, 10
  s_cselect_b32 s39, s61, s41
  v_mfma_f32_16x16x32_bf16 v[44:47], v[204:207], v[220:223], v[44:47]
  s_add_u32 s39, s39, 51200
  v_mfma_f32_16x16x32_bf16 v[48:51], v[204:207], v[224:227], v[48:51]
  buffer_load_dwordx4 v[160:163], v3, s[12:15], s39 offen offset:0 sc1
  v_mfma_f32_16x16x32_bf16 v[52:55], v[204:207], v[228:231], v[52:55]
  v_mfma_f32_16x16x32_bf16 v[56:59], v[208:211], v[216:219], v[56:59]
  buffer_load_dwordx4 v[164:167], v3, s[12:15], s39 offen offset:1024 sc1
  v_mfma_f32_16x16x32_bf16 v[60:63], v[208:211], v[220:223], v[60:63]
  v_mfma_f32_16x16x32_bf16 v[64:67], v[208:211], v[224:227], v[64:67]
  buffer_load_dwordx4 v[168:171], v3, s[12:15], s39 offen offset:2048 sc1
  v_mfma_f32_16x16x32_bf16 v[68:71], v[208:211], v[228:231], v[68:71]
  v_mfma_f32_16x16x32_bf16 v[72:75], v[212:215], v[216:219], v[72:75]
  buffer_load_dwordx4 v[172:175], v3, s[12:15], s39 offen offset:3072 sc1
  v_mfma_f32_16x16x32_bf16 v[76:79], v[212:215], v[220:223], v[76:79]
  v_mfma_f32_16x16x32_bf16 v[80:83], v[212:215], v[224:227], v[80:83]
  buffer_load_dwordx4 v[176:179], v4, s[12:15], s39 offen sc1
  s_lshl_b32 s53, s32, 4
  s_add_u32 s52, s52, s53
  v_mfma_f32_16x16x32_bf16 v[84:87], v[212:215], v[228:231], v[84:87]
  s_mul_i32 s52, s52, 1280
  s_mul_i32 s53, s34, 160
  s_add_u32 s52, s52, s53
  v_lshlrev_b32 v240, 3, v244
  v_lshrrev_b32 v245, 3, v2
  v_lshlrev_b32 v245, 12, v245
  v_and_b32 v246, 7, v2
  v_lshl_add_u32 v242, v246, 4, v245
  s_waitcnt vmcnt(18)
  v_mfma_f32_16x16x32_bf16 v[8:11], v[88:91], v[108:111], v[8:11]
  s_cmp_le_u32 s62, 11
  s_cselect_b32 s50, s60, s40
  s_add_u32 s50, s50, 45056
  v_mfma_f32_16x16x32_bf16 v[12:15], v[88:91], v[112:115], v[12:15]
  v_mfma_f32_16x16x32_bf16 v[16:19], v[88:91], v[116:119], v[16:19]
  buffer_load_dwordx4 v[216:219], v3, s[8:11], s50 offen offset:0 sc1
  v_mfma_f32_16x16x32_bf16 v[20:23], v[88:91], v[120:123], v[20:23]
  v_mfma_f32_16x16x32_bf16 v[24:27], v[92:95], v[108:111], v[24:27]
  buffer_load_dwordx4 v[220:223], v3, s[8:11], s50 offen offset:1024 sc1
  v_mfma_f32_16x16x32_bf16 v[28:31], v[92:95], v[112:115], v[28:31]
  v_mfma_f32_16x16x32_bf16 v[32:35], v[92:95], v[116:119], v[32:35]
  buffer_load_dwordx4 v[224:227], v3, s[8:11], s50 offen offset:2048 sc1
  v_mfma_f32_16x16x32_bf16 v[36:39], v[92:95], v[120:123], v[36:39]
  v_mfma_f32_16x16x32_bf16 v[40:43], v[96:99], v[108:111], v[40:43]
  buffer_load_dwordx4 v[228:231], v3, s[8:11], s50 offen offset:3072 sc1
  s_cmp_le_u32 s62, 11
  s_cselect_b32 s51, s61, s41
  v_mfma_f32_16x16x32_bf16 v[44:47], v[96:99], v[112:115], v[44:47]
  s_add_u32 s51, s51, 56320
  v_mfma_f32_16x16x32_bf16 v[48:51], v[96:99], v[116:119], v[48:51]
  buffer_load_dwordx4 v[196:199], v3, s[12:15], s51 offen offset:0 sc1
  v_mfma_f32_16x16x32_bf16 v[52:55], v[96:99], v[120:123], v[52:55]
  v_mfma_f32_16x16x32_bf16 v[56:59], v[100:103], v[108:111], v[56:59]
  buffer_load_dwordx4 v[200:203], v3, s[12:15], s51 offen offset:1024 sc1
  v_mfma_f32_16x16x32_bf16 v[60:63], v[100:103], v[112:115], v[60:63]
  v_mfma_f32_16x16x32_bf16 v[64:67], v[100:103], v[116:119], v[64:67]
  buffer_load_dwordx4 v[204:207], v3, s[12:15], s51 offen offset:2048 sc1
  v_mfma_f32_16x16x32_bf16 v[68:71], v[100:103], v[120:123], v[68:71]
  v_mfma_f32_16x16x32_bf16 v[72:75], v[104:107], v[108:111], v[72:75]
  buffer_load_dwordx4 v[208:211], v3, s[12:15], s51 offen offset:3072 sc1
  v_mfma_f32_16x16x32_bf16 v[76:79], v[104:107], v[112:115], v[76:79]
  v_mfma_f32_16x16x32_bf16 v[80:83], v[104:107], v[116:119], v[80:83]
  buffer_load_dwordx4 v[212:215], v4, s[12:15], s51 offen sc1
  s_sub_u32 s55, s32, 1
  s_and_b32 s55, s55, 3
  v_mfma_f32_16x16x32_bf16 v[84:87], v[104:107], v[120:123], v[84:87]
  s_mul_i32 s55, s55, 16128
  v_add_u32 v235, s55, v235
  v_add_u32 v236, s55, v236
  v_add_u32 v237, s55, v237
  v_mul_u32_u24 v241, 176, v243
  v_lshl_add_u32 v241, v244, 3, v241
  v_add_u32 v241, s55, v241
  v_lshrrev_b32 v245, 5, v2
  s_waitcnt vmcnt(18)
  v_mfma_f32_16x16x32_bf16 v[8:11], v[124:127], v[144:147], v[8:11]
  s_cmp_le_u32 s62, 12
  s_cselect_b32 s38, s60, s40
  s_add_u32 s38, s38, 49152
  v_mfma_f32_16x16x32_bf16 v[12:15], v[124:127], v[148:151], v[12:15]
  v_mfma_f32_16x16x32_bf16 v[16:19], v[124:127], v[152:155], v[16:19]
  buffer_load_dwordx4 v[108:111], v3, s[8:11], s38 offen offset:0 sc1
  v_mfma_f32_16x16x32_bf16 v[20:23], v[124:127], v[156:159], v[20:23]
  v_mfma_f32_16x16x32_bf16 v[24:27], v[128:131], v[144:147], v[24:27]
  buffer_load_dwordx4 v[112:115], v3, s[8:11], s38 offen offset:1024 sc1
  v_mfma_f32_16x16x32_bf16 v[28:31], v[128:131], v[148:151], v[28:31]
  v_mfma_f32_16x16x32_bf16 v[32:35], v[128:131], v[152:155], v[32:35]
  buffer_load_dwordx4 v[116:119], v3, s[8:11], s38 offen offset:2048 sc1
  v_mfma_f32_16x16x32_bf16 v[36:39], v[128:131], v[156:159], v[36:39]
  v_mfma_f32_16x16x32_bf16 v[40:43], v[132:135], v[144:147], v[40:43]
  buffer_load_dwordx4 v[120:123], v3, s[8:11], s38 offen offset:3072 sc1
  s_cmp_le_u32 s62, 12
  s_cselect_b32 s39, s61, s41
  v_mfma_f32_16x16x32_bf16 v[44:47], v[132:135], v[148:151], v[44:47]
  s_add_u32 s39, s39, 61440
  v_mfma_f32_16x16x32_bf16 v[48:51], v[132:135], v[152:155], v[48:51]
  buffer_load_dwordx4 v[88:91], v3, s[12:15], s39 offen offset:0 sc1
  v_mfma_f32_16x16x32_bf16 v[52:55], v[132:135], v[156:159], v[52:55]
  v_mfma_f32_16x16x32_bf16 v[56:59], v[136:139], v[144:147], v[56:59]
  buffer_load_dwordx4 v[92:95], v3, s[12:15], s39 offen offset:1024 sc1
  v_mfma_f32_16x16x32_bf16 v[60:63], v[136:139], v[148:151], v[60:63]
  v_mfma_f32_16x16x32_bf16 v[64:67], v[136:139], v[152:155], v[64:67]
  buffer_load_dwordx4 v[96:99], v3, s[12:15], s39 offen offset:2048 sc1
  v_mfma_f32_16x16x32_bf16 v[68:71], v[136:139], v[156:159], v[68:71]
  v_mfma_f32_16x16x32_bf16 v[72:75], v[140:143], v[144:147], v[72:75]
  buffer_load_dwordx4 v[100:103], v3, s[12:15], s39 offen offset:3072 sc1
  v_mfma_f32_16x16x32_bf16 v[76:79], v[140:143], v[148:151], v[76:79]
  v_mfma_f32_16x16x32_bf16 v[80:83], v[140:143], v[152:155], v[80:83]
  buffer_load_dwordx4 v[104:107], v4, s[12:15], s39 offen sc1
  v_mul_u32_u24 v245, 1040, v245
  v_and_b32 v246, 1, v244
  v_mfma_f32_16x16x32_bf16 v[84:87], v[140:143], v[156:159], v[84:87]
  v_lshl_add_u32 v245, v246, 9, v245
  v_bfe_u32 v246, v2, 2, 2
  v_lshl_add_u32 v245, v246, 7, v245
  v_and_b32 v246, 3, v2
  v_lshl_add_u32 v245, v246, 3, v245
  s_lshl_b32 s55, s32, 5
  s_add_u32 s55, s55, 64512
  v_add_u32 v239, s55, v245
  s_waitcnt vmcnt(18)
  v_mfma_f32_16x16x32_bf16 v[8:11], v[160:163], v[180:183], v[8:11]
  buffer_load_dwordx4 v[144:147], v3, s[8:11], s42 offen offset:0 sc1
  v_mfma_f32_16x16x32_bf16 v[12:15], v[160:163], v[184:187], v[12:15]
  v_mfma_f32_16x16x32_bf16 v[16:19], v[160:163], v[188:191], v[16:19]
  buffer_load_dwordx4 v[148:151], v3, s[8:11], s42 offen offset:1024 sc1
  v_mfma_f32_16x16x32_bf16 v[20:23], v[160:163], v[192:195], v[20:23]
  v_mfma_f32_16x16x32_bf16 v[24:27], v[164:167], v[180:183], v[24:27]
  buffer_load_dwordx4 v[152:155], v3, s[8:11], s42 offen offset:2048 sc1
  v_mfma_f32_16x16x32_bf16 v[28:31], v[164:167], v[184:187], v[28:31]
  v_mfma_f32_16x16x32_bf16 v[32:35], v[164:167], v[188:191], v[32:35]
  buffer_load_dwordx4 v[156:159], v3, s[8:11], s42 offen offset:3072 sc1
  v_mfma_f32_16x16x32_bf16 v[36:39], v[164:167], v[192:195], v[36:39]
  v_mfma_f32_16x16x32_bf16 v[40:43], v[168:171], v[180:183], v[40:43]
  buffer_load_dwordx4 v[124:127], v3, s[12:15], s43 offen offset:0 sc1
  v_mfma_f32_16x16x32_bf16 v[44:47], v[168:171], v[184:187], v[44:47]
  v_mfma_f32_16x16x32_bf16 v[48:51], v[168:171], v[188:191], v[48:51]
  buffer_load_dwordx4 v[128:131], v3, s[12:15], s43 offen offset:1024 sc1
  v_mfma_f32_16x16x32_bf16 v[52:55], v[168:171], v[192:195], v[52:55]
  v_mfma_f32_16x16x32_bf16 v[56:59], v[172:175], v[180:183], v[56:59]
  buffer_load_dwordx4 v[132:135], v3, s[12:15], s43 offen offset:2048 sc1
  v_mfma_f32_16x16x32_bf16 v[60:63], v[172:175], v[184:187], v[60:63]
  v_mfma_f32_16x16x32_bf16 v[64:67], v[172:175], v[188:191], v[64:67]
  buffer_load_dwordx4 v[136:139], v3, s[12:15], s43 offen offset:3072 sc1
  v_mfma_f32_16x16x32_bf16 v[68:71], v[172:175], v[192:195], v[68:71]
  v_mfma_f32_16x16x32_bf16 v[72:75], v[176:179], v[180:183], v[72:75]
  buffer_load_dwordx4 v[140:143], v4, s[12:15], s43 offen sc1
  v_mfma_f32_16x16x32_bf16 v[76:79], v[176:179], v[184:187], v[76:79]
  v_mfma_f32_16x16x32_bf16 v[80:83], v[176:179], v[188:191], v[80:83]
  v_mfma_f32_16x16x32_bf16 v[84:87], v[176:179], v[192:195], v[84:87]
  s_waitcnt vmcnt(18)
  v_mfma_f32_16x16x32_bf16 v[8:11], v[196:199], v[216:219], v[8:11]
  buffer_load_dword v5, v6, s[4:7], 0 offen sc1
  v_mfma_f32_16x16x32_bf16 v[12:15], v[196:199], v[220:223], v[12:15]
  v_mfma_f32_16x16x32_bf16 v[16:19], v[196:199], v[224:227], v[16:19]
  buffer_load_dwordx4 v[160:163], v232, s[16:19], s52 offen
  v_mfma_f32_16x16x32_bf16 v[20:23], v[196:199], v[228:231], v[20:23]
  v_mfma_f32_16x16x32_bf16 v[24:27], v[200:203], v[216:219], v[24:27]
  buffer_load_dwordx4 v[164:167], v233, s[16:19], s52 offen
  v_mfma_f32_16x16x32_bf16 v[28:31], v[200:203], v[220:223], v[28:31]
  v_mfma_f32_16x16x32_bf16 v[32:35], v[200:203], v[224:227], v[32:35]
  buffer_load_dwordx4 v[168:171], v234, s[16:19], s52 offen
  v_mfma_f32_16x16x32_bf16 v[36:39], v[200:203], v[228:231], v[36:39]
  v_mfma_f32_16x16x32_bf16 v[40:43], v[204:207], v[216:219], v[40:43]
  buffer_load_dwordx2 v[172:173], v240, s[44:47], s53 offen offset:0
  v_mfma_f32_16x16x32_bf16 v[44:47], v[204:207], v[220:223], v[44:47]
  v_mfma_f32_16x16x32_bf16 v[48:51], v[204:207], v[224:227], v[48:51]
  buffer_load_dwordx2 v[174:175], v240, s[44:47], s53 offen offset:32
  v_mfma_f32_16x16x32_bf16 v[52:55], v[204:207], v[228:231], v[52:55]
  v_mfma_f32_16x16x32_bf16 v[56:59], v[208:211], v[216:219], v[56:59]
  buffer_load_dwordx2 v[176:177], v240, s[44:47], s53 offen offset:64
  v_mfma_f32_16x16x32_bf16 v[60:63], v[208:211], v[220:223], v[60:63]
  v_mfma_f32_16x16x32_bf16 v[64:67], v[208:211], v[224:227], v[64:67]
  buffer_load_dwordx2 v[178:179], v240, s[44:47], s53 offen offset:96
  v_mfma_f32_16x16x32_bf16 v[68:71], v[208:211], v[228:231], v[68:71]
  v_mfma_f32_16x16x32_bf16 v[72:75], v[212:215], v[216:219], v[72:75]
  buffer_load_dwordx2 v[180:181], v240, s[44:47], s53 offen offset:128
  v_mfma_f32_16x16x32_bf16 v[76:79], v[212:215], v[220:223], v[76:79]
  v_mfma_f32_16x16x32_bf16 v[80:83], v[212:215], v[224:227], v[80:83]
  v_mfma_f32_16x16x32_bf16 v[84:87], v[212:215], v[228:231], v[84:87]
  s_waitcnt vmcnt(18)
  v_mfma_f32_16x16x32_bf16 v[8:11], v[88:91], v[108:111], v[8:11]
  v_mfma_f32_16x16x32_bf16 v[12:15], v[88:91], v[112:115], v[12:15]
  v_mfma_f32_16x16x32_bf16 v[16:19], v[88:91], v[116:119], v[16:19]
  v_mfma_f32_16x16x32_bf16 v[20:23], v[88:91], v[120:123], v[20:23]
  v_mfma_f32_16x16x32_bf16 v[24:27], v[92:95], v[108:111], v[24:27]
  v_mfma_f32_16x16x32_bf16 v[28:31], v[92:95], v[112:115], v[28:31]
  v_mfma_f32_16x16x32_bf16 v[32:35], v[92:95], v[116:119], v[32:35]
  v_mfma_f32_16x16x32_bf16 v[36:39], v[92:95], v[120:123], v[36:39]
  v_mfma_f32_16x16x32_bf16 v[40:43], v[96:99], v[108:111], v[40:43]
  v_mfma_f32_16x16x32_bf16 v[44:47], v[96:99], v[112:115], v[44:47]
  v_mfma_f32_16x16x32_bf16 v[48:51], v[96:99], v[116:119], v[48:51]
  v_mfma_f32_16x16x32_bf16 v[52:55], v[96:99], v[120:123], v[52:55]
  v_mfma_f32_16x16x32_bf16 v[56:59], v[100:103], v[108:111], v[56:59]
  v_mfma_f32_16x16x32_bf16 v[60:63], v[100:103], v[112:115], v[60:63]
  v_mfma_f32_16x16x32_bf16 v[64:67], v[100:103], v[116:119], v[64:67]
  v_mfma_f32_16x16x32_bf16 v[68:71], v[100:103], v[120:123], v[68:71]
  v_mfma_f32_16x16x32_bf16 v[72:75], v[104:107], v[108:111], v[72:75]
  v_mfma_f32_16x16x32_bf16 v[76:79], v[104:107], v[112:115], v[76:79]
  v_mfma_f32_16x16x32_bf16 v[80:83], v[104:107], v[116:119], v[80:83]
  v_mfma_f32_16x16x32_bf16 v[84:87], v[104:107], v[120:123], v[84:87]
  s_waitcnt vmcnt(9)
  v_mfma_f32_16x16x32_bf16 v[8:11], v[124:127], v[144:147], v[8:11]
  v_mfma_f32_16x16x32_bf16 v[12:15], v[124:127], v[148:151], v[12:15]
  v_mfma_f32_16x16x32_bf16 v[16:19], v[124:127], v[152:155], v[16:19]
  v_mfma_f32_16x16x32_bf16 v[20:23], v[124:127], v[156:159], v[20:23]
  v_mfma_f32_16x16x32_bf16 v[24:27], v[128:131], v[144:147], v[24:27]
  v_mfma_f32_16x16x32_bf16 v[28:31], v[128:131], v[148:151], v[28:31]
  v_mfma_f32_16x16x32_bf16 v[32:35], v[128:131], v[152:155], v[32:35]
  v_mfma_f32_16x16x32_bf16 v[36:39], v[128:131], v[156:159], v[36:39]
  v_mfma_f32_16x16x32_bf16 v[40:43], v[132:135], v[144:147], v[40:43]
  v_mfma_f32_16x16x32_bf16 v[44:47], v[132:135], v[148:151], v[44:47]
  v_mfma_f32_16x16x32_bf16 v[48:51], v[132:135], v[152:155], v[48:51]
  v_mfma_f32_16x16x32_bf16 v[52:55], v[132:135], v[156:159], v[52:55]
  v_mfma_f32_16x16x32_bf16 v[56:59], v[136:139], v[144:147], v[56:59]
  v_mfma_f32_16x16x32_bf16 v[60:63], v[136:139], v[148:151], v[60:63]
  v_mfma_f32_16x16x32_bf16 v[64:67], v[136:139], v[152:155], v[64:67]
  v_mfma_f32_16x16x32_bf16 v[68:71], v[136:139], v[156:159], v[68:71]
  v_mfma_f32_16x16x32_bf16 v[72:75], v[140:143], v[144:147], v[72:75]
  v_mfma_f32_16x16x32_bf16 v[76:79], v[140:143], v[148:151], v[76:79]
  v_mfma_f32_16x16x32_bf16 v[80:83], v[140:143], v[152:155], v[80:83]
  v_mfma_f32_16x16x32_bf16 v[84:87], v[140:143], v[156:159], v[84:87]
  s_cmp_lg_u32 s32, 0
  s_cbranch_scc1 L_g2_w1
  ds_write_b128 v238, v[12:15] offset:0
  ds_write_b128 v238, v[28:31] offset:64
  ds_write_b128 v238, v[44:47] offset:128
  ds_write_b128 v238, v[60:63] offset:192
  ds_write_b128 v238, v[76:79] offset:256
  ds_write_b128 v238, v[16:19] offset:5376
  ds_write_b128 v238, v[32:35] offset:5440
  ds_write_b128 v238, v[48:51] offset:5504
  ds_write_b128 v238, v[64:67] offset:5568
  ds_write_b128 v238, v[80:83] offset:5632
  ds_write_b128 v238, v[20:23] offset:10752
  ds_write_b128 v238, v[36:39] offset:10816
  ds_write_b128 v238, v[52:55] offset:10880
  ds_write_b128 v238, v[68:71] offset:10944
  ds_write_b128 v238, v[84:87] offset:11008
  s_branch L_g2_wdone
L_g2_w1:
  s_cmp_lg_u32 s32, 1
  s_cbranch_scc1 L_g2_w2
  ds_write_b128 v238, v[16:19] offset:16128
  ds_write_b128 v238, v[32:35] offset:16192
  ds_write_b128 v238, v[48:51] offset:16256
  ds_write_b128 v238, v[64:67] offset:16320
  ds_write_b128 v238, v[80:83] offset:16384
  ds_write_b128 v238, v[20:23] offset:21504
  ds_write_b128 v238, v[36:39] offset:21568
  ds_write_b128 v238, v[52:55] offset:21632
  ds_write_b128 v238, v[68:71] offset:21696
  ds_write_b128 v238, v[84:87] offset:21760
  ds_write_b128 v238, v[8:11] offset:26880
  ds_write_b128 v238, v[24:27] offset:26944
  ds_write_b128 v238, v[40:43] offset:27008
  ds_write_b128 v238, v[56:59] offset:27072
  ds_write_b128 v238, v[72:75] offset:27136
  v_mov_b32 v8, v12
  v_mov_b32 v9, v13
  v_mov_b32 v10, v14
  v_mov_b32 v11, v15
  v_mov_b32 v24, v28
  v_mov_b32 v25, v29
  v_mov_b32 v26, v30
  v_mov_b32 v27, v31
  v_mov_b32 v40, v44
  v_mov_b32 v41, v45
  v_mov_b32 v42, v46
  v_mov_b32 v43, v47
  v_mov_b32 v56, v60
  v_mov_b32 v57, v61
  v_mov_b32 v58, v62
  v_mov_b32 v59, v63
  v_mov_b32 v72, v76
  v_mov_b32 v73, v77
  v_mov_b32 v74, v78
  v_mov_b32 v75, v79
  s_branch L_g2_wdone
L_g2_w2:
  s_cmp_lg_u32 s32, 2
  s_cbranch_scc1 L_g2_w3
  ds_write_b128 v238, v[20:23] offset:32256
  ds_write_b128 v238, v[36:39] offset:32320
  ds_write_b128 v238, v[52:55] offset:32384
  ds_write_b128 v238, v[68:71] offset:32448
  ds_write_b128 v238, v[84:87] offset:32512
  ds_write_b128 v238, v[8:11] offset:37632
  ds_write_b128 v238, v[24:27] offset:37696
  ds_write_b128 v238, v[40:43] offset:37760
  ds_write_b128 v238, v[56:59] offset:37824
  ds_write_b128 v238, v[72:75] offset:37888
  ds_write_b128 v238, v[12:15] offset:43008
  ds_write_b128 v238, v[28:31] offset:43072
  ds_write_b128 v238, v[44:47] offset:43136
  ds_write_b128 v238, v[60:63] offset:43200
  ds_write_b128 v238, v[76:79] offset:43264
  v_mov_b32 v8, v16
  v_mov_b32 v9, v17
  v_mov_b32 v10, v18
  v_mov_b32 v11, v19
  v_mov_b32 v24, v32
  v_mov_b32 v25, v33
  v_mov_b32 v26, v34
  v_mov_b32 v27, v35
  v_mov_b32 v40, v48
  v_mov_b32 v41, v49
  v_mov_b32 v42, v50
  v_mov_b32 v43, v51
  v_mov_b32 v56, v64
  v_mov_b32 v57, v65
  v_mov_b32 v58, v66
  v_mov_b32 v59, v67
  v_mov_b32 v72, v80
  v_mov_b32 v73, v81
  v_mov_b32 v74, v82
  v_mov_b32 v75, v83
  s_branch L_g2_wdone
L_g2_w3:
  ds_write_b128 v238, v[8:11] offset:48384
  ds_write_b128 v238, v[24:27] offset:48448
  ds_write_b128 v238, v[40:43] offset:48512
  ds_write_b128 v238, v[56:59] offset:48576
  ds_write_b128 v238, v[72:75] offset:48640
  ds_write_b128 v238, v[12:15] offset:53760
  ds_write_b128 v238, v[28:31] offset:53824
  ds_write_b128 v238, v[44:47] offset:53888
  ds_write_b128 v238, v[60:63] offset:53952
  ds_write_b128 v238, v[76:79] offset:54016
  ds_write_b128 v238, v[16:19] offset:59136
  ds_write_b128 v238, v[32:35] offset:59200
  ds_write_b128 v238, v[48:51] offset:59264
  ds_write_b128 v238, v[64:67] offset:59328
  ds_write_b128 v238, v[80:83] offset:59392
  v_mov_b32 v8, v20
  v_mov_b32 v9, v21
  v_mov_b32 v10, v22
  v_mov_b32 v11, v23
  v_mov_b32 v24, v36
  v_mov_b32 v25, v37
  v_mov_b32 v26, v38
  v_mov_b32 v27, v39
  v_mov_b32 v40, v52
  v_mov_b32 v41, v53
  v_mov_b32 v42, v54
  v_mov_b32 v43, v55
  v_mov_b32 v56, v68
  v_mov_b32 v57, v69
  v_mov_b32 v58, v70
  v_mov_b32 v59, v71
  v_mov_b32 v72, v84
  v_mov_b32 v73, v85
  v_mov_b32 v74, v86
  v_mov_b32 v75, v87
L_g2_wdone:
  s_waitcnt vmcnt(0)
  s_cmp_lg_u32 s32, 0
  s_cbranch_scc1 L_g2_rdy
  s_mov_b32 s58, 4000
L_g2_chk:
  v_cmp_eq_u32 vcc, s59, v5
  s_nop 3
  s_cmp_eq_u64 vcc, -1
  s_cbranch_scc1 L_g2_chk_ok
  s_sub_u32 s58, s58, 1
  s_cmp_eq_u32 s58, 0
  s_cbranch_scc1 L_g2_chk_ok
  s_sleep 8
  buffer_load_dword v5, v6, s[4:7], 0 offen sc1
  s_waitcnt vmcnt(0)
  s_branch L_g2_chk
L_g2_chk_ok:
L_g2_rdy:
  s_waitcnt lgkmcnt(0)
  s_barrier
  s_mul_i32 s48, s34, 327680
  s_lshl_b32 s49, s33, 7
  s_add_u32 s48, s48, s49
  s_lshl_b32 s49, s32, 15
  s_add_u32 s48, s48, s49
  s_mul_i32 s50, s32, 1040
  s_add_u32 s50, s50, 64512
  s_add_u32 m0, s50, 0
  s_add_u32 s49, s48, 0
  buffer_load_dwordx4 v242, s[20:23], s49 offen sc1 lds
  s_add_u32 m0, s50, 4160
  s_add_u32 s49, s48, 131072
  buffer_load_dwordx4 v242, s[20:23], s49 offen sc1 lds
  s_add_u32 m0, s50, 8320
  s_add_u32 s49, s48, 262144
  buffer_load_dwordx4 v242, s[20:23], s49 offen sc1 lds
  s_sub_u32 s55, s32, 1
  s_and_b32 s55, s55, 3
  s_mul_i32 s55, s55, 3
  s_add_u32 s55, s55, 0
  s_mul_i32 s55, s55, 5376
  v_add_u32 v6, s55, v238
  ds_read_b128 v[88:91], v6 offset:0
  ds_read_b128 v[92:95], v6 offset:64
  ds_read_b128 v[96:99], v6 offset:128
  ds_read_b128 v[100:103], v6 offset:192
  ds_read_b128 v[104:107], v6 offset:256
  s_sub_u32 s55, s32, 2
  s_and_b32 s55, s55, 3
  s_mul_i32 s55, s55, 3
  s_add_u32 s55, s55, 1
  s_mul_i32 s55, s55, 5376
  v_add_u32 v6, s55, v238
  ds_read_b128 v[108:111], v6 offset:0
  ds_read_b128 v[112:115], v6 offset:64
  ds_read_b128 v[116:119], v6 offset:128
  ds_read_b128 v[120:123], v6 offset:192
  ds_read_b128 v[124:127], v6 offset:256
  s_sub_u32 s55, s32, 3
  s_and_b32 s55, s55, 3
  s_mul_i32 s55, s55, 3
  s_add_u32 s55, s55, 2
  s_mul_i32 s55, s55, 5376
  v_add_u32 v6, s55, v238
  ds_read_b128 v[128:131], v6 offset:0
  ds_read_b128 v[132:135], v6 offset:64
  ds_read_b128 v[136:139], v6 offset:128
  ds_read_b128 v[140:143], v6 offset:192
  ds_read_b128 v[144:147], v6 offset:256
  s_waitcnt lgkmcnt(10)
  v_add_f32 v8, v8, v88
  v_add_f32 v9, v9, v89
  v_add_f32 v10, v10, v90
  v_add_f32 v11, v11, v91
  v_add_f32 v24, v24, v92
  v_add_f32 v25, v25, v93
  v_add_f32 v26, v26, v94
  v_add_f32 v27, v27, v95
  v_add_f32 v40, v40, v96
  v_add_f32 v41, v41, v97
  v_add_f32 v42, v42, v98
  v_add_f32 v43, v43, v99
  v_add_f32 v56, v56, v100
  v_add_f32 v57, v57, v101
  v_add_f32 v58, v58, v102
  v_add_f32 v59, v59, v103
  v_add_f32 v72, v72, v104
  v_add_f32 v73, v73, v105
  v_add_f32 v74, v74, v106
  v_add_f32 v75, v75, v107
  s_waitcnt lgkmcnt(5)
  v_add_f32 v8, v8, v108
  v_add_f32 v9, v9, v109
  v_add_f32 v10, v10, v110
  v_add_f32 v11, v11, v111
  v_add_f32 v24, v24, v112
  v_add_f32 v25, v25, v113
  v_add_f32 v26, v26, v114
  v_add_f32 v27, v27, v115
  v_add_f32 v40, v40, v116
  v_add_f32 v41, v41, v117
  v_add_f32 v42, v42, v118
  v_add_f32 v43, v43, v119
  v_add_f32 v56, v56, v120
  v_add_f32 v57, v57, v121
  v_add_f32 v58, v58, v122
  v_add_f32 v59, v59, v123
  v_add_f32 v72, v72, v124
  v_add_f32 v73, v73, v125
  v_add_f32 v74, v74, v126
  v_add_f32 v75, v75, v127
  s_waitcnt lgkmcnt(0)
  v_add_f32 v8, v8, v128
  v_add_f32 v9, v9, v129
  v_add_f32 v10, v10, v130
  v_add_f32 v11, v11, v131
  v_add_f32 v24, v24, v132
  v_add_f32 v25, v25, v133
  v_add_f32 v26, v26, v134
  v_add_f32 v27, v27, v135
  v_add_f32 v40, v40, v136
  v_add_f32 v41, v41, v137
  v_add_f32 v42, v42, v138
  v_add_f32 v43, v43, v139
  v_add_f32 v56, v56, v140
  v_add_f32 v57, v57, v141
  v_add_f32 v58, v58, v142
  v_add_f32 v59, v59, v143
  v_add_f32 v72, v72, v144
  v_add_f32 v73, v73, v145
  v_add_f32 v74, v74, v146
  v_add_f32 v75, v75, v147
  v_lshlrev_b32 v108, 16, v172
  v_and_b32 v109, 0xffff0000, v172
  v_lshlrev_b32 v110, 16, v173
  v_and_b32 v111, 0xffff0000, v173
  v_add_f32 v8, v8, v108
  v_add_f32 v9, v9, v109
  v_add_f32 v10, v10, v110
  v_add_f32 v11, v11, v111
  v_lshlrev_b32 v112, 16, v174
  v_and_b32 v113, 0xffff0000, v174
  v_lshlrev_b32 v114, 16, v175
  v_and_b32 v115, 0xffff0000, v175
  v_add_f32 v24, v24, v112
  v_add_f32 v25, v25, v113
  v_add_f32 v26, v26, v114
  v_add_f32 v27, v27, v115
  v_lshlrev_b32 v116, 16, v176
  v_and_b32 v117, 0xffff0000, v176
  v_lshlrev_b32 v118, 16, v177
  v_and_b32 v119, 0xffff0000, v177
  v_add_f32 v40, v40, v116
  v_add_f32 v41, v41, v117
  v_add_f32 v42, v42, v118
  v_add_f32 v43, v43, v119
  v_lshlrev_b32 v120, 16, v178
  v_and_b32 v121, 0xffff0000, v178
  v_lshlrev_b32 v122, 16, v179
  v_and_b32 v123, 0xffff0000, v179
  v_add_f32 v56, v56, v120
  v_add_f32 v57, v57, v121
  v_add_f32 v58, v58, v122
  v_add_f32 v59, v59, v123
  v_lshlrev_b32 v124, 16, v180
  v_and_b32 v125, 0xffff0000, v180
  v_lshlrev_b32 v126, 16, v181
  v_and_b32 v127, 0xffff0000, v181
  v_add_f32 v72, v72, v124
  v_add_f32 v73, v73, v125
  v_add_f32 v74, v74, v126
  v_add_f32 v75, v75, v127
  s_mov_b32 s54, 0xbfb8aa3b
  v_mul_f32 v88, s54, v8
  v_mul_f32 v89, s54, v9
  v_mul_f32 v90, s54, v10
  v_mul_f32 v91, s54, v11
  v_mul_f32 v92, s54, v24
  v_mul_f32 v93, s54, v25
  v_mul_f32 v94, s54, v26
  v_mul_f32 v95, s54, v27
  v_mul_f32 v96, s54, v40
  v_mul_f32 v97, s54, v41
  v_mul_f32 v98, s54, v42
  v_mul_f32 v99, s54, v43
  v_mul_f32 v100, s54, v56
  v_mul_f32 v101, s54, v57
  v_mul_f32 v102, s54, v58
  v_mul_f32 v103, s54, v59
  v_mul_f32 v104, s54, v72
  v_mul_f32 v105, s54, v73
  v_mul_f32 v106, s54, v74
  v_mul_f32 v107, s54, v75
  v_exp_f32 v88, v88
  v_exp_f32 v89, v89
  v_exp_f32 v90, v90
  v_exp_f32 v91, v91
  v_exp_f32 v92, v92
  v_exp_f32 v93, v93
  v_exp_f32 v94, v94
  v_exp_f32 v95, v95
  v_exp_f32 v96, v96
  v_exp_f32 v97, v97
  v_exp_f32 v98, v98
  v_exp_f32 v99, v99
  v_exp_f32 v100, v100
  v_exp_f32 v101, v101
  v_exp_f32 v102, v102
  v_exp_f32 v103, v103
  v_exp_f32 v104, v104
  v_exp_f32 v105, v105
  v_exp_f32 v106, v106
  v_exp_f32 v107, v107
  v_add_f32 v88, 1.0, v88
  v_add_f32 v89, 1.0, v89
  v_add_f32 v90, 1.0, v90
  v_add_f32 v91, 1.0, v91
  v_add_f32 v92, 1.0, v92
  v_add_f32 v93, 1.0, v93
  v_add_f32 v94, 1.0, v94
  v_add_f32 v95, 1.0, v95
  v_add_f32 v96, 1.0, v96
  v_add_f32 v97, 1.0, v97
  v_add_f32 v98, 1.0, v98
  v_add_f32 v99, 1.0, v99
  v_add_f32 v100, 1.0, v100
  v_add_f32 v101, 1.0, v101
  v_add_f32 v102, 1.0, v102
  v_add_f32 v103, 1.0, v103
  v_add_f32 v104, 1.0, v104
  v_add_f32 v105, 1.0, v105
  v_add_f32 v106, 1.0, v106
  v_add_f32 v107, 1.0, v107
  v_rcp_f32 v88, v88
  v_rcp_f32 v89, v89
  v_rcp_f32 v90, v90
  v_rcp_f32 v91, v91
  v_rcp_f32 v92, v92
  v_rcp_f32 v93, v93
  v_rcp_f32 v94, v94
  v_rcp_f32 v95, v95
  v_rcp_f32 v96, v96
  v_rcp_f32 v97, v97
  v_rcp_f32 v98, v98
  v_rcp_f32 v99, v99
  v_rcp_f32 v100, v100
  v_rcp_f32 v101, v101
  v_rcp_f32 v102, v102
  v_rcp_f32 v103, v103
  v_rcp_f32 v104, v104
  v_rcp_f32 v105, v105
  v_rcp_f32 v106, v106
  v_rcp_f32 v107, v107
  v_mul_f32 v8, v8, v88
  v_mul_f32 v9, v9, v89
  v_mul_f32 v10, v10, v90
  v_mul_f32 v11, v11, v91
  v_mul_f32 v24, v24, v92
  v_mul_f32 v25, v25, v93
  v_mul_f32 v26, v26, v94
  v_mul_f32 v27, v27, v95
  v_mul_f32 v40, v40, v96
  v_mul_f32 v41, v41, v97
  v_mul_f32 v42, v42, v98
  v_mul_f32 v43, v43, v99
  v_mul_f32 v56, v56, v100
  v_mul_f32 v57, v57, v101
  v_mul_f32 v58, v58, v102
  v_mul_f32 v59, v59, v103
  v_mul_f32 v72, v72, v104
  v_mul_f32 v73, v73, v105
  v_mul_f32 v74, v74, v106
  v_mul_f32 v75, v75, v107
  v_lshlrev_b32 v112, 16, v160
  v_and_b32 v113, 0xffff0000, v160
  v_lshlrev_b32 v114, 16, v161
  v_and_b32 v115, 0xffff0000, v161
  v_lshlrev_b32 v116, 16, v162
  v_and_b32 v117, 0xffff0000, v162
  v_lshlrev_b32 v118, 16, v163
  v_and_b32 v119, 0xffff0000, v163
  v_lshlrev_b32 v120, 16, v164
  v_and_b32 v121, 0xffff0000, v164
  v_lshlrev_b32 v122, 16, v165
  v_and_b32 v123, 0xffff0000, v165
  v_lshlrev_b32 v124, 16, v166
  v_and_b32 v125, 0xffff0000, v166
  v_lshlrev_b32 v126, 16, v167
  v_and_b32 v127, 0xffff0000, v167
  v_lshlrev_b32 v128, 16, v168
  v_and_b32 v129, 0xffff0000, v168
  v_lshlrev_b32 v130, 16, v169
  v_and_b32 v131, 0xffff0000, v169
  v_lshlrev_b32 v132, 16, v170
  v_and_b32 v133, 0xffff0000, v170
  v_lshlrev_b32 v134, 16, v171
  v_and_b32 v135, 0xffff0000, v171
  s_waitcnt vmcnt(0)
  s_barrier
  ds_read_b64_tr_b16 v[168:169], v239 offset:0
  ds_read_b64_tr_b16 v[170:171], v239 offset:2080
  ds_read_b64_tr_b16 v[172:173], v239 offset:4160
  ds_read_b64_tr_b16 v[174:175], v239 offset:6240
  ds_read_b64_tr_b16 v[176:177], v239 offset:8320
  s_waitcnt lgkmcnt(4)
  v_lshlrev_b32 v88, 16, v168
  v_and_b32 v89, 0xffff0000, v168
  v_lshlrev_b32 v90, 16, v169
  v_and_b32 v91, 0xffff0000, v169
  v_mul_f32 v8, v8, v88
  v_mul_f32 v9, v9, v89
  v_mul_f32 v10, v10, v90
  v_mul_f32 v11, v11, v91
  v_cvt_pk_bf16_f32 v8, v8, v9
  v_cvt_pk_bf16_f32 v9, v10, v11
  ds_write_b64 v241, v[8:9] offset:0
  s_waitcnt lgkmcnt(4)
  v_lshlrev_b32 v92, 16, v170
  v_and_b32 v93, 0xffff0000, v170
  v_lshlrev_b32 v94, 16, v171
  v_and_b32 v95, 0xffff0000, v171
  v_mul_f32 v24, v24, v92
  v_mul_f32 v25, v25, v93
  v_mul_f32 v26, v26, v94
  v_mul_f32 v27, v27, v95
  v_cvt_pk_bf16_f32 v24, v24, v25
  v_cvt_pk_bf16_f32 v25, v26, v27
  ds_write_b64 v241, v[24:25] offset:32
  s_waitcnt lgkmcnt(4)
  v_lshlrev_b32 v88, 16, v172
  v_and_b32 v89, 0xffff0000, v172
  v_lshlrev_b32 v90, 16, v173
  v_and_b32 v91, 0xffff0000, v173
  v_mul_f32 v40, v40, v88
  v_mul_f32 v41, v41, v89
  v_mul_f32 v42, v42, v90
  v_mul_f32 v43, v43, v91
  v_cvt_pk_bf16_f32 v40, v40, v41
  v_cvt_pk_bf16_f32 v41, v42, v43
  ds_write_b64 v241, v[40:41] offset:64
  s_waitcnt lgkmcnt(4)
  v_lshlrev_b32 v92, 16, v174
  v_and_b32 v93, 0xffff0000, v174
  v_lshlrev_b32 v94, 16, v175
  v_and_b32 v95, 0xffff0000, v175
  v_mul_f32 v56, v56, v92
  v_mul_f32 v57, v57, v93
  v_mul_f32 v58, v58, v94
  v_mul_f32 v59, v59, v95
  v_cvt_pk_bf16_f32 v56, v56, v57
  v_cvt_pk_bf16_f32 v57, v58, v59
  ds_write_b64 v241, v[56:57] offset:96
  s_waitcnt lgkmcnt(4)
  v_lshlrev_b32 v88, 16, v176
  v_and_b32 v89, 0xffff0000, v176
  v_lshlrev_b32 v90, 16, v177
  v_and_b32 v91, 0xffff0000, v177
  v_mul_f32 v72, v72, v88
  v_mul_f32 v73, v73, v89
  v_mul_f32 v74, v74, v90
  v_mul_f32 v75, v75, v91
  v_cvt_pk_bf16_f32 v72, v72, v73
  v_cvt_pk_bf16_f32 v73, v74, v75
  ds_write_b64 v241, v[72:73] offset:128
  s_waitcnt lgkmcnt(0)
  ds_read_b128 v[136:139], v235
  ds_read_b128 v[140:143], v236
  ds_read_b128 v[144:147], v237
  s_waitcnt lgkmcnt(2)
  v_lshlrev_b32 v148, 16, v136
  v_and_b32 v149, 0xffff0000, v136
  v_add_f32 v148, v148, v112
  v_add_f32 v149, v149, v113
  v_cvt_pk_bf16_f32 v136, v148, v149
  v_lshlrev_b32 v150, 16, v137
  v_and_b32 v151, 0xffff0000, v137
  v_add_f32 v150, v150, v114
  v_add_f32 v151, v151, v115
  v_cvt_pk_bf16_f32 v137, v150, v151
  v_lshlrev_b32 v148, 16, v138
  v_and_b32 v149, 0xffff0000, v138
  v_add_f32 v148, v148, v116
  v_add_f32 v149, v149, v117
  v_cvt_pk_bf16_f32 v138, v148, v149
  v_lshlrev_b32 v150, 16, v139
  v_and_b32 v151, 0xffff0000, v139
  v_add_f32 v150, v150, v118
  v_add_f32 v151, v151, v119
  v_cvt_pk_bf16_f32 v139, v150, v151
  buffer_store_dwordx4 v[136:139], v232, s[24:27], s52 offen
  s_waitcnt lgkmcnt(1)
  v_lshlrev_b32 v148, 16, v140
  v_and_b32 v149, 0xffff0000, v140
  v_add_f32 v148, v148, v120
  v_add_f32 v149, v149, v121
  v_cvt_pk_bf16_f32 v140, v148, v149
  v_lshlrev_b32 v150, 16, v141
  v_and_b32 v151, 0xffff0000, v141
  v_add_f32 v150, v150, v122
  v_add_f32 v151, v151, v123
  v_cvt_pk_bf16_f32 v141, v150, v151
  v_lshlrev_b32 v148, 16, v142
  v_and_b32 v149, 0xffff0000, v142
  v_add_f32 v148, v148, v124
  v_add_f32 v149, v149, v125
  v_cvt_pk_bf16_f32 v142, v148, v149
  v_lshlrev_b32 v150, 16, v143
  v_and_b32 v151, 0xffff0000, v143
  v_add_f32 v150, v150, v126
  v_add_f32 v151, v151, v127
  v_cvt_pk_bf16_f32 v143, v150, v151
  buffer_store_dwordx4 v[140:143], v233, s[24:27], s52 offen
  s_waitcnt lgkmcnt(0)
  v_lshlrev_b32 v148, 16, v144
  v_and_b32 v149, 0xffff0000, v144
  v_add_f32 v148, v148, v128
  v_add_f32 v149, v149, v129
  v_cvt_pk_bf16_f32 v144, v148, v149
  v_lshlrev_b32 v150, 16, v145
  v_and_b32 v151, 0xffff0000, v145
  v_add_f32 v150, v150, v130
  v_add_f32 v151, v151, v131
  v_cvt_pk_bf16_f32 v145, v150, v151
  v_lshlrev_b32 v148, 16, v146
  v_and_b32 v149, 0xffff0000, v146
  v_add_f32 v148, v148, v132
  v_add_f32 v149, v149, v133
  v_cvt_pk_bf16_f32 v146, v148, v149
  v_lshlrev_b32 v150, 16, v147
  v_and_b32 v151, 0xffff0000, v147
  v_add_f32 v150, v150, v134
  v_add_f32 v151, v151, v135
  v_cvt_pk_bf16_f32 v147, v150, v151
  buffer_store_dwordx4 v[144:147], v234, s[24:27], s52 offen
  s_waitcnt vmcnt(0)
  s_endpgm
L_S:
  s_setprio 2
  s_sub_u32 s62, s2, 256
  s_mul_i32 s60, s62, 2341
  s_lshr_b32 s60, s60, 16
  s_mul_i32 s56, s60, 28
  s_sub_u32 s56, s62, s56
  s_cmp_eq_u32 s32, 3
  s_cbranch_scc1 L_w2f
  s_cmp_ge_u32 s56, 24
  s_cbranch_scc1 L_kc_two
  s_mul_i32 s61, s56, 3
  s_branch L_kc_map
L_kc_two:
  s_cmp_ge_u32 s32, 2
  s_cbranch_scc1 L_tlb
  s_lshl_b32 s61, s56, 1
  s_add_u32 s61, s61, 24
L_kc_map:
  s_add_u32 s61, s61, s32
  s_mul_i32 s55, s60, 80
  s_add_u32 s61, s61, s55
  v_and_b32 v21, 31, v2
  v_lshlrev_b32 v21, 3, v21
  s_lshl_b32 s40, s61, 8
  s_lshl_b32 s41, s61, 1
  v_mov_b32 v38, 0
  s_waitcnt lgkmcnt(0)
  s_mov_b32 s24, s74
  s_mov_b32 s25, s75
  s_mov_b32 s26, 1280
  s_mov_b32 s27, 0x00020000
  s_mov_b32 s8, s66
  s_mov_b32 s9, s67
  s_mov_b32 s10, 163840
  s_mov_b32 s11, 0x00020000
  s_mov_b32 s12, s68
  s_mov_b32 s13, s69
  s_mov_b32 s14, 163840
  s_mov_b32 s15, 0x00020000
  s_mov_b32 s16, s70
  s_mov_b32 s17, s71
  s_mov_b32 s18, 163840
  s_mov_b32 s19, 0x00020000
  s_mov_b32 s20, s72
  s_mov_b32 s21, s73
  s_mov_b32 s22, 163840
  s_mov_b32 s23, 0x00020000
  buffer_load_ushort v20, v38, s[24:27], s41 offen
  buffer_load_dwordx2 v[232:233], v21, s[8:11], s40 offen
  buffer_load_dwordx2 v[234:235], v21, s[12:15], s40 offen
  buffer_load_dwordx2 v[236:237], v21, s[16:19], s40 offen
  buffer_load_dwordx2 v[238:239], v21, s[20:23], s40 offen
  s_mov_b32 s44, s76
  s_mov_b32 s45, s77
  s_mov_b32 s46, 1280
  s_mov_b32 s47, 0x00020000
  buffer_load_ushort v240, v38, s[44:47], s41 offen
  s_mov_b32 s28, s90
  s_mov_b32 s29, s91
  s_mov_b32 s30, 256
  s_mov_b32 s31, 0x00020000
  v_mov_b32 v243, 0
  buffer_load_dword v242, v243, s[28:31], 0 offen sc1
  s_mul_i32 s33, s32, 13440
  s_add_u32 s4, s92, 20185088
  s_addc_u32 s5, s93, 0
  s_mov_b32 s6, 16384
  s_mov_b32 s7, 0x00020000
  v_lshrrev_b32 v25, 5, v2
  v_cmp_eq_u32 vcc, 0, v25
  v_mov_b32 v38, 1.0
  v_mov_b32 v39, 0x41800000
  v_cndmask_b32 v23, v38, v39, vcc
  v_mov_b32 v39, -1.0
  v_cndmask_b32 v24, v38, v39, vcc
  v_and_b32 v38, 15, v2
  v_lshrrev_b32 v39, 4, v2
  v_lshlrev_b32 v39, 4, v39
  v_add_u32 v39, s33, v39
  v_mov_b32 v41, v38
  v_mul_u32_u24 v41, 288, v41
  v_add_u32 v26, v41, v39
  v_lshlrev_b32 v40, 0, v38
  v_mov_b32 v41, v40
  v_subrev_u32 v42, 16, v40
  v_lshrrev_b32 v42, 1, v42
  v_add_u32 v42, 16, v42
  v_cmp_le_u32 vcc, 16, v40
  s_nop 1
  v_cndmask_b32 v41, v41, v42, vcc
  v_subrev_u32 v42, 32, v40
  v_lshrrev_b32 v42, 2, v42
  v_add_u32 v42, 24, v42
  v_cmp_le_u32 vcc, 32, v40
  s_nop 1
  v_cndmask_b32 v41, v41, v42, vcc
  v_subrev_u32 v42, 64, v40
  v_lshrrev_b32 v42, 3, v42
  v_add_u32 v42, 32, v42
  v_cmp_le_u32 vcc, 64, v40
  s_nop 1
  v_cndmask_b32 v41, v41, v42, vcc
  v_mul_u32_u24 v41, 288, v41
  v_add_u32 v41, 128, v41
  v_add_u32 v30, v41, v39
  v_and_b32 v41, 7, v38
  v_add_u32 v41, 16, v41
  v_mul_u32_u24 v41, 288, v41
  v_add_u32 v27, v41, v39
  v_lshlrev_b32 v40, 1, v38
  v_mov_b32 v41, v40
  v_subrev_u32 v42, 16, v40
  v_lshrrev_b32 v42, 1, v42
  v_add_u32 v42, 16, v42
  v_cmp_le_u32 vcc, 16, v40
  s_nop 1
  v_cndmask_b32 v41, v41, v42, vcc
  v_subrev_u32 v42, 32, v40
  v_lshrrev_b32 v42, 2, v42
  v_add_u32 v42, 24, v42
  v_cmp_le_u32 vcc, 32, v40
  s_nop 1
  v_cndmask_b32 v41, v41, v42, vcc
  v_subrev_u32 v42, 64, v40
  v_lshrrev_b32 v42, 3, v42
  v_add_u32 v42, 32, v42
  v_cmp_le_u32 vcc, 64, v40
  s_nop 1
  v_cndmask_b32 v41, v41, v42, vcc
  v_mul_u32_u24 v41, 288, v41
  v_add_u32 v41, 128, v41
  v_add_u32 v31, v41, v39
  v_and_b32 v41, 7, v38
  v_add_u32 v41, 24, v41
  v_mul_u32_u24 v41, 288, v41
  v_add_u32 v28, v41, v39
  v_lshlrev_b32 v40, 2, v38
  v_mov_b32 v41, v40
  v_subrev_u32 v42, 16, v40
  v_lshrrev_b32 v42, 1, v42
  v_add_u32 v42, 16, v42
  v_cmp_le_u32 vcc, 16, v40
  s_nop 1
  v_cndmask_b32 v41, v41, v42, vcc
  v_subrev_u32 v42, 32, v40
  v_lshrrev_b32 v42, 2, v42
  v_add_u32 v42, 24, v42
  v_cmp_le_u32 vcc, 32, v40
  s_nop 1
  v_cndmask_b32 v41, v41, v42, vcc
  v_subrev_u32 v42, 64, v40
  v_lshrrev_b32 v42, 3, v42
  v_add_u32 v42, 32, v42
  v_cmp_le_u32 vcc, 64, v40
  s_nop 1
  v_cndmask_b32 v41, v41, v42, vcc
  v_mul_u32_u24 v41, 288, v41
  v_add_u32 v41, 128, v41
  v_add_u32 v32, v41, v39
  v_min_u32 v41, 8, v38
  v_add_u32 v41, 32, v41
  v_mul_u32_u24 v41, 288, v41
  v_add_u32 v29, v41, v39
  v_lshlrev_b32 v40, 3, v38
  v_mov_b32 v41, v40
  v_subrev_u32 v42, 16, v40
  v_lshrrev_b32 v42, 1, v42
  v_add_u32 v42, 16, v42
  v_cmp_le_u32 vcc, 16, v40
  s_nop 1
  v_cndmask_b32 v41, v41, v42, vcc
  v_subrev_u32 v42, 32, v40
  v_lshrrev_b32 v42, 2, v42
  v_add_u32 v42, 24, v42
  v_cmp_le_u32 vcc, 32, v40
  s_nop 1
  v_cndmask_b32 v41, v41, v42, vcc
  v_subrev_u32 v42, 64, v40
  v_lshrrev_b32 v42, 3, v42
  v_add_u32 v42, 32, v42
  v_cmp_le_u32 vcc, 64, v40
  s_nop 1
  v_cndmask_b32 v41, v41, v42, vcc
  v_mul_u32_u24 v41, 288, v41
  v_add_u32 v41, 128, v41
  v_add_u32 v33, v41, v39
  v_cmp_eq_u32 vcc, 0, v25
  s_mov_b32 s41, 1069066811
  s_mov_b32 s42, 1042479491
  s_mov_b32 m0, s33
  s_waitcnt vmcnt(6)
  v_lshlrev_b32 v20, 16, v20
  v_mul_f32 v20, s41, v20
  v_exp_f32 v20, v20
  s_nop 0
  v_cvt_pk_bf16_f32 v20, v20, v20
  v_and_b32 v20, 0xffff0000, v20
  s_waitcnt vmcnt(2)
  s_setprio 0
  v_lshlrev_b32 v4, 16, v232
  v_lshlrev_b32 v5, 16, v234
  v_lshlrev_b32 v6, 16, v236
  v_lshlrev_b32 v7, 16, v238
  v_and_b32 v8, 0xffff0000, v232
  v_and_b32 v9, 0xffff0000, v234
  v_and_b32 v10, 0xffff0000, v236
  v_and_b32 v11, 0xffff0000, v238
  v_lshlrev_b32 v12, 16, v233
  v_lshlrev_b32 v13, 16, v235
  v_lshlrev_b32 v14, 16, v237
  v_lshlrev_b32 v15, 16, v239
  v_and_b32 v16, 0xffff0000, v233
  v_and_b32 v17, 0xffff0000, v235
  v_and_b32 v18, 0xffff0000, v237
  v_and_b32 v19, 0xffff0000, v239
  v_mul_f32 v4, s41, v4
  v_mul_f32 v8, s41, v8
  v_mul_f32 v12, s41, v12
  v_mul_f32 v16, s41, v16
  v_exp_f32 v4, v4
  v_exp_f32 v8, v8
  v_exp_f32 v12, v12
  v_exp_f32 v16, v16
  v_mul_f32 v5, v5, v20
  v_mul_f32 v9, v9, v20
  v_mul_f32 v13, v13, v20
  v_mul_f32 v17, v17, v20
  v_cvt_pk_bf16_f32 v4, v4, v4
  v_cvt_pk_bf16_f32 v8, v8, v8
  v_cvt_pk_bf16_f32 v12, v12, v12
  v_cvt_pk_bf16_f32 v16, v16, v16
  v_mul_f32 v6, v6, v20
  v_mul_f32 v10, v10, v20
  v_mul_f32 v14, v14, v20
  v_mul_f32 v18, v18, v20
  v_and_b32 v4, 0xffff0000, v4
  v_and_b32 v8, 0xffff0000, v8
  v_and_b32 v12, 0xffff0000, v12
  v_and_b32 v16, 0xffff0000, v16
  v_mul_f32 v7, v7, v20
  v_mul_f32 v11, v11, v20
  v_mul_f32 v15, v15, v20
  v_mul_f32 v19, v19, v20
  v_mul_f32 v4, v4, v20
  v_mul_f32 v8, v8, v20
  v_mul_f32 v12, v12, v20
  v_mul_f32 v16, v16, v20
  v_mul_f32 v5, v5, v23
  v_mul_f32 v9, v9, v23
  v_mul_f32 v13, v13, v23
  v_mul_f32 v17, v17, v23
  v_mul_f32 v4, v4, v23
  v_mul_f32 v8, v8, v23
  v_mul_f32 v12, v12, v23
  v_mul_f32 v16, v16, v23
  v_mul_f32 v5, s42, v5
  v_mul_f32 v9, s42, v9
  v_mul_f32 v13, s42, v13
  v_mul_f32 v17, s42, v17
  v_mul_f32 v4, s41, v4
  v_mul_f32 v8, s41, v8
  v_mul_f32 v12, s41, v12
  v_mul_f32 v16, s41, v16
  v_fract_f32 v5, v5
  v_fract_f32 v9, v9
  v_fract_f32 v13, v13
  v_fract_f32 v17, v17
  v_exp_f32 v4, -v4
  v_exp_f32 v8, -v8
  v_exp_f32 v12, -v12
  v_exp_f32 v16, -v16
  v_add_f32 v6, v6, v6
  v_add_f32 v10, v10, v10
  v_add_f32 v14, v14, v14
  v_add_f32 v18, v18, v18
  v_mul_f32 v7, -2.0, v7
  v_mul_f32 v11, -2.0, v11
  v_mul_f32 v15, -2.0, v15
  v_mul_f32 v19, -2.0, v19
  v_cndmask_b32 v6, 1.0, v6, vcc
  v_cndmask_b32 v10, 1.0, v10, vcc
  v_cndmask_b32 v14, 1.0, v14, vcc
  v_cndmask_b32 v18, 1.0, v18, vcc
  v_cndmask_b32 v7, 0, v7, vcc
  v_cndmask_b32 v11, 0, v11, vcc
  v_cndmask_b32 v15, 0, v15, vcc
  v_cndmask_b32 v19, 0, v19, vcc
  v_cos_f32 v232, v5
  v_sin_f32 v233, v5
  v_cos_f32 v234, v9
  v_sin_f32 v235, v9
  v_cos_f32 v236, v13
  v_sin_f32 v237, v13
  v_cos_f32 v238, v17
  v_sin_f32 v239, v17
  v_mul_f32 v233, v233, v24
  v_mul_f32 v235, v235, v24
  v_mul_f32 v237, v237, v24
  v_mul_f32 v239, v239, v24
  v_mul_f32 v5, v233, v4
  v_mul_f32 v4, v232, v4
  v_mul_f32 v9, v235, v8
  v_mul_f32 v8, v234, v8
  v_mul_f32 v13, v237, v12
  v_mul_f32 v12, v236, v12
  v_mul_f32 v17, v239, v16
  v_mul_f32 v16, v238, v16
  v_cvt_pk_bf16_f32 v64, v6, v7
  v_cvt_pk_bf16_f32 v106, v10, v11
  v_mul_f32 v36, v6, v4
  v_mul_f32 v37, v6, v5
  v_mul_f32 v46, v10, v8
  v_mul_f32 v47, v10, v9
  v_fma_f32 v34, -v7, v5, v36
  v_fma_f32 v35, v7, v4, v37
  v_fma_f32 v44, -v11, v9, v46
  v_fma_f32 v45, v11, v8, v47
  v_cvt_pk_bf16_f32 v65, v34, v35
  v_cvt_pk_bf16_f32 v107, v44, v45
  v_mul_f32 v36, v34, v4
  v_mul_f32 v37, v34, v5
  v_mul_f32 v46, v44, v8
  v_mul_f32 v47, v44, v9
  v_fma_f32 v6, -v35, v5, v36
  v_fma_f32 v7, v35, v4, v37
  v_fma_f32 v10, -v45, v9, v46
  v_fma_f32 v11, v45, v8, v47
  v_cvt_pk_bf16_f32 v66, v6, v7
  v_cvt_pk_bf16_f32 v108, v10, v11
  v_mul_f32 v36, v6, v4
  v_mul_f32 v37, v6, v5
  v_mul_f32 v46, v10, v8
  v_mul_f32 v47, v10, v9
  v_fma_f32 v34, -v7, v5, v36
  v_fma_f32 v35, v7, v4, v37
  v_fma_f32 v44, -v11, v9, v46
  v_fma_f32 v45, v11, v8, v47
  v_cvt_pk_bf16_f32 v67, v34, v35
  v_cvt_pk_bf16_f32 v109, v44, v45
  v_mul_f32 v36, v34, v4
  v_mul_f32 v37, v34, v5
  v_mul_f32 v46, v44, v8
  v_mul_f32 v47, v44, v9
  v_fma_f32 v6, -v35, v5, v36
  v_fma_f32 v7, v35, v4, v37
  v_fma_f32 v10, -v45, v9, v46
  v_fma_f32 v11, v45, v8, v47
  v_cvt_pk_bf16_f32 v68, v6, v7
  v_cvt_pk_bf16_f32 v110, v10, v11
  v_mul_f32 v36, v6, v4
  v_mul_f32 v37, v6, v5
  v_mul_f32 v46, v10, v8
  v_mul_f32 v47, v10, v9
  v_fma_f32 v34, -v7, v5, v36
  v_fma_f32 v35, v7, v4, v37
  v_fma_f32 v44, -v11, v9, v46
  v_fma_f32 v45, v11, v8, v47
  v_cvt_pk_bf16_f32 v69, v34, v35
  v_cvt_pk_bf16_f32 v111, v44, v45
  v_mul_f32 v36, v34, v4
  v_mul_f32 v37, v34, v5
  v_mul_f32 v46, v44, v8
  v_mul_f32 v47, v44, v9
  v_fma_f32 v6, -v35, v5, v36
  v_fma_f32 v7, v35, v4, v37
  v_fma_f32 v10, -v45, v9, v46
  v_fma_f32 v11, v45, v8, v47
  v_cvt_pk_bf16_f32 v70, v6, v7
  v_cvt_pk_bf16_f32 v112, v10, v11
  v_mul_f32 v36, v6, v4
  v_mul_f32 v37, v6, v5
  v_mul_f32 v46, v10, v8
  v_mul_f32 v47, v10, v9
  v_fma_f32 v34, -v7, v5, v36
  v_fma_f32 v35, v7, v4, v37
  v_fma_f32 v44, -v11, v9, v46
  v_fma_f32 v45, v11, v8, v47
  v_cvt_pk_bf16_f32 v71, v34, v35
  v_cvt_pk_bf16_f32 v113, v44, v45
  v_mul_f32 v36, v34, v4
  v_mul_f32 v37, v34, v5
  v_mul_f32 v46, v44, v8
  v_mul_f32 v47, v44, v9
  v_fma_f32 v6, -v35, v5, v36
  v_fma_f32 v7, v35, v4, v37
  v_fma_f32 v10, -v45, v9, v46
  v_fma_f32 v11, v45, v8, v47
  v_cvt_pk_bf16_f32 v72, v6, v7
  v_cvt_pk_bf16_f32 v114, v10, v11
  v_mul_f32 v36, v6, v4
  v_mul_f32 v37, v6, v5
  v_mul_f32 v46, v10, v8
  v_mul_f32 v47, v10, v9
  v_fma_f32 v34, -v7, v5, v36
  v_fma_f32 v35, v7, v4, v37
  v_fma_f32 v44, -v11, v9, v46
  v_fma_f32 v45, v11, v8, v47
  v_cvt_pk_bf16_f32 v73, v34, v35
  v_cvt_pk_bf16_f32 v115, v44, v45
  v_mul_f32 v36, v34, v4
  v_mul_f32 v37, v34, v5
  v_mul_f32 v46, v44, v8
  v_mul_f32 v47, v44, v9
  v_fma_f32 v6, -v35, v5, v36
  v_fma_f32 v7, v35, v4, v37
  v_fma_f32 v10, -v45, v9, v46
  v_fma_f32 v11, v45, v8, v47
  v_cvt_pk_bf16_f32 v74, v6, v7
  v_cvt_pk_bf16_f32 v116, v10, v11
  v_mul_f32 v36, v6, v4
  v_mul_f32 v37, v6, v5
  v_mul_f32 v46, v10, v8
  v_mul_f32 v47, v10, v9
  v_fma_f32 v34, -v7, v5, v36
  v_fma_f32 v35, v7, v4, v37
  v_fma_f32 v44, -v11, v9, v46
  v_fma_f32 v45, v11, v8, v47
  v_cvt_pk_bf16_f32 v75, v34, v35
  v_cvt_pk_bf16_f32 v117, v44, v45
  v_mul_f32 v36, v34, v4
  v_mul_f32 v37, v34, v5
  v_mul_f32 v46, v44, v8
  v_mul_f32 v47, v44, v9
  v_fma_f32 v6, -v35, v5, v36
  v_fma_f32 v7, v35, v4, v37
  v_fma_f32 v10, -v45, v9, v46
  v_fma_f32 v11, v45, v8, v47
  v_cvt_pk_bf16_f32 v76, v6, v7
  v_cvt_pk_bf16_f32 v118, v10, v11
  v_mul_f32 v36, v6, v4
  v_mul_f32 v37, v6, v5
  v_mul_f32 v46, v10, v8
  v_mul_f32 v47, v10, v9
  v_fma_f32 v34, -v7, v5, v36
  v_fma_f32 v35, v7, v4, v37
  v_fma_f32 v44, -v11, v9, v46
  v_fma_f32 v45, v11, v8, v47
  v_cvt_pk_bf16_f32 v77, v34, v35
  v_cvt_pk_bf16_f32 v119, v44, v45
  v_mul_f32 v36, v34, v4
  v_mul_f32 v37, v34, v5
  v_mul_f32 v46, v44, v8
  v_mul_f32 v47, v44, v9
  v_fma_f32 v6, -v35, v5, v36
  v_fma_f32 v7, v35, v4, v37
  v_fma_f32 v10, -v45, v9, v46
  v_fma_f32 v11, v45, v8, v47
  v_cvt_pk_bf16_f32 v78, v6, v7
  v_cvt_pk_bf16_f32 v120, v10, v11
  v_mul_f32 v36, v6, v4
  v_mul_f32 v37, v6, v5
  v_mul_f32 v46, v10, v8
  v_mul_f32 v47, v10, v9
  v_fma_f32 v34, -v7, v5, v36
  v_fma_f32 v35, v7, v4, v37
  v_fma_f32 v44, -v11, v9, v46
  v_fma_f32 v45, v11, v8, v47
  v_cvt_pk_bf16_f32 v79, v34, v35
  v_cvt_pk_bf16_f32 v121, v44, v45
  v_mul_f32 v36, v34, v4
  v_mul_f32 v37, v34, v5
  v_mul_f32 v46, v44, v8
  v_mul_f32 v47, v44, v9
  v_fma_f32 v6, -v35, v5, v36
  v_fma_f32 v7, v35, v4, v37
  v_fma_f32 v10, -v45, v9, v46
  v_fma_f32 v11, v45, v8, v47
  v_cvt_pk_bf16_f32 v80, v6, v7
  v_cvt_pk_bf16_f32 v122, v10, v11
  v_mul_f32 v36, v5, v5
  v_mul_f32 v37, v4, v5
  v_mul_f32 v46, v9, v9
  v_mul_f32 v47, v8, v9
  v_fma_f32 v4, v4, v4, -v36
  v_add_f32 v5, v37, v37
  v_fma_f32 v8, v8, v8, -v46
  v_add_f32 v9, v47, v47
  v_mul_f32 v36, v6, v4
  v_mul_f32 v37, v6, v5
  v_mul_f32 v46, v10, v8
  v_mul_f32 v47, v10, v9
  v_fma_f32 v34, -v7, v5, v36
  v_fma_f32 v35, v7, v4, v37
  v_fma_f32 v44, -v11, v9, v46
  v_fma_f32 v45, v11, v8, v47
  v_cvt_pk_bf16_f32 v81, v34, v35
  v_cvt_pk_bf16_f32 v123, v44, v45
  v_mul_f32 v36, v34, v4
  v_mul_f32 v37, v34, v5
  v_mul_f32 v46, v44, v8
  v_mul_f32 v47, v44, v9
  v_fma_f32 v6, -v35, v5, v36
  v_fma_f32 v7, v35, v4, v37
  v_fma_f32 v10, -v45, v9, v46
  v_fma_f32 v11, v45, v8, v47
  v_cvt_pk_bf16_f32 v82, v6, v7
  v_cvt_pk_bf16_f32 v124, v10, v11
  v_mul_f32 v36, v6, v4
  v_mul_f32 v37, v6, v5
  v_mul_f32 v46, v10, v8
  v_mul_f32 v47, v10, v9
  v_fma_f32 v34, -v7, v5, v36
  v_fma_f32 v35, v7, v4, v37
  v_fma_f32 v44, -v11, v9, v46
  v_fma_f32 v45, v11, v8, v47
  v_cvt_pk_bf16_f32 v83, v34, v35
  v_cvt_pk_bf16_f32 v125, v44, v45
  v_mul_f32 v36, v34, v4
  v_mul_f32 v37, v34, v5
  v_mul_f32 v46, v44, v8
  v_mul_f32 v47, v44, v9
  v_fma_f32 v6, -v35, v5, v36
  v_fma_f32 v7, v35, v4, v37
  v_fma_f32 v10, -v45, v9, v46
  v_fma_f32 v11, v45, v8, v47
  v_cvt_pk_bf16_f32 v84, v6, v7
  v_cvt_pk_bf16_f32 v126, v10, v11
  v_mul_f32 v36, v6, v4
  v_mul_f32 v37, v6, v5
  v_mul_f32 v46, v10, v8
  v_mul_f32 v47, v10, v9
  v_fma_f32 v34, -v7, v5, v36
  v_fma_f32 v35, v7, v4, v37
  v_fma_f32 v44, -v11, v9, v46
  v_fma_f32 v45, v11, v8, v47
  v_cvt_pk_bf16_f32 v85, v34, v35
  v_cvt_pk_bf16_f32 v127, v44, v45
  v_mul_f32 v36, v34, v4
  v_mul_f32 v37, v34, v5
  v_mul_f32 v46, v44, v8
  v_mul_f32 v47, v44, v9
  v_fma_f32 v6, -v35, v5, v36
  v_fma_f32 v7, v35, v4, v37
  v_fma_f32 v10, -v45, v9, v46
  v_fma_f32 v11, v45, v8, v47
  v_cvt_pk_bf16_f32 v86, v6, v7
  v_cvt_pk_bf16_f32 v128, v10, v11
  v_mul_f32 v36, v6, v4
  v_mul_f32 v37, v6, v5
  v_mul_f32 v46, v10, v8
  v_mul_f32 v47, v10, v9
  v_fma_f32 v34, -v7, v5, v36
  v_fma_f32 v35, v7, v4, v37
  v_fma_f32 v44, -v11, v9, v46
  v_fma_f32 v45, v11, v8, v47
  v_cvt_pk_bf16_f32 v87, v34, v35
  v_cvt_pk_bf16_f32 v129, v44, v45
  v_mul_f32 v36, v34, v4
  v_mul_f32 v37, v34, v5
  v_mul_f32 v46, v44, v8
  v_mul_f32 v47, v44, v9
  v_fma_f32 v6, -v35, v5, v36
  v_fma_f32 v7, v35, v4, v37
  v_fma_f32 v10, -v45, v9, v46
  v_fma_f32 v11, v45, v8, v47
  v_cvt_pk_bf16_f32 v88, v6, v7
  v_cvt_pk_bf16_f32 v130, v10, v11
  v_mul_f32 v36, v5, v5
  v_mul_f32 v37, v4, v5
  v_mul_f32 v46, v9, v9
  v_mul_f32 v47, v8, v9
  v_fma_f32 v4, v4, v4, -v36
  v_add_f32 v5, v37, v37
  v_fma_f32 v8, v8, v8, -v46
  v_add_f32 v9, v47, v47
  v_mul_f32 v36, v6, v4
  v_mul_f32 v37, v6, v5
  v_mul_f32 v46, v10, v8
  v_mul_f32 v47, v10, v9
  v_fma_f32 v34, -v7, v5, v36
  v_fma_f32 v35, v7, v4, v37
  v_fma_f32 v44, -v11, v9, v46
  v_fma_f32 v45, v11, v8, v47
  v_cvt_pk_bf16_f32 v89, v34, v35
  v_cvt_pk_bf16_f32 v131, v44, v45
  v_mul_f32 v36, v34, v4
  v_mul_f32 v37, v34, v5
  v_mul_f32 v46, v44, v8
  v_mul_f32 v47, v44, v9
  v_fma_f32 v6, -v35, v5, v36
  v_fma_f32 v7, v35, v4, v37
  v_fma_f32 v10, -v45, v9, v46
  v_fma_f32 v11, v45, v8, v47
  v_cvt_pk_bf16_f32 v90, v6, v7
  v_cvt_pk_bf16_f32 v132, v10, v11
  v_mul_f32 v36, v6, v4
  v_mul_f32 v37, v6, v5
  v_mul_f32 v46, v10, v8
  v_mul_f32 v47, v10, v9
  v_fma_f32 v34, -v7, v5, v36
  v_fma_f32 v35, v7, v4, v37
  v_fma_f32 v44, -v11, v9, v46
  v_fma_f32 v45, v11, v8, v47
  v_cvt_pk_bf16_f32 v91, v34, v35
  v_cvt_pk_bf16_f32 v133, v44, v45
  v_mul_f32 v36, v34, v4
  v_mul_f32 v37, v34, v5
  v_mul_f32 v46, v44, v8
  v_mul_f32 v47, v44, v9
  v_fma_f32 v6, -v35, v5, v36
  v_fma_f32 v7, v35, v4, v37
  v_fma_f32 v10, -v45, v9, v46
  v_fma_f32 v11, v45, v8, v47
  v_cvt_pk_bf16_f32 v92, v6, v7
  v_cvt_pk_bf16_f32 v134, v10, v11
  v_mul_f32 v36, v6, v4
  v_mul_f32 v37, v6, v5
  v_mul_f32 v46, v10, v8
  v_mul_f32 v47, v10, v9
  v_fma_f32 v34, -v7, v5, v36
  v_fma_f32 v35, v7, v4, v37
  v_fma_f32 v44, -v11, v9, v46
  v_fma_f32 v45, v11, v8, v47
  v_cvt_pk_bf16_f32 v93, v34, v35
  v_cvt_pk_bf16_f32 v135, v44, v45
  v_mul_f32 v36, v34, v4
  v_mul_f32 v37, v34, v5
  v_mul_f32 v46, v44, v8
  v_mul_f32 v47, v44, v9
  v_fma_f32 v6, -v35, v5, v36
  v_fma_f32 v7, v35, v4, v37
  v_fma_f32 v10, -v45, v9, v46
  v_fma_f32 v11, v45, v8, v47
  v_cvt_pk_bf16_f32 v94, v6, v7
  v_cvt_pk_bf16_f32 v136, v10, v11
  v_mul_f32 v36, v6, v4
  v_mul_f32 v37, v6, v5
  v_mul_f32 v46, v10, v8
  v_mul_f32 v47, v10, v9
  v_fma_f32 v34, -v7, v5, v36
  v_fma_f32 v35, v7, v4, v37
  v_fma_f32 v44, -v11, v9, v46
  v_fma_f32 v45, v11, v8, v47
  v_cvt_pk_bf16_f32 v95, v34, v35
  v_cvt_pk_bf16_f32 v137, v44, v45
  v_mul_f32 v36, v34, v4
  v_mul_f32 v37, v34, v5
  v_mul_f32 v46, v44, v8
  v_mul_f32 v47, v44, v9
  v_fma_f32 v6, -v35, v5, v36
  v_fma_f32 v7, v35, v4, v37
  v_fma_f32 v10, -v45, v9, v46
  v_fma_f32 v11, v45, v8, v47
  v_cvt_pk_bf16_f32 v96, v6, v7
  v_cvt_pk_bf16_f32 v138, v10, v11
  v_mul_f32 v36, v5, v5
  v_mul_f32 v37, v4, v5
  v_mul_f32 v46, v9, v9
  v_mul_f32 v47, v8, v9
  v_fma_f32 v4, v4, v4, -v36
  v_add_f32 v5, v37, v37
  v_fma_f32 v8, v8, v8, -v46
  v_add_f32 v9, v47, v47
  v_mul_f32 v36, v6, v4
  v_mul_f32 v37, v6, v5
  v_mul_f32 v46, v10, v8
  v_mul_f32 v47, v10, v9
  v_fma_f32 v34, -v7, v5, v36
  v_fma_f32 v35, v7, v4, v37
  v_fma_f32 v44, -v11, v9, v46
  v_fma_f32 v45, v11, v8, v47
  v_cvt_pk_bf16_f32 v97, v34, v35
  v_cvt_pk_bf16_f32 v139, v44, v45
  v_mul_f32 v36, v34, v4
  v_mul_f32 v37, v34, v5
  v_mul_f32 v46, v44, v8
  v_mul_f32 v47, v44, v9
  v_fma_f32 v6, -v35, v5, v36
  v_fma_f32 v7, v35, v4, v37
  v_fma_f32 v10, -v45, v9, v46
  v_fma_f32 v11, v45, v8, v47
  v_cvt_pk_bf16_f32 v98, v6, v7
  v_cvt_pk_bf16_f32 v140, v10, v11
  v_mul_f32 v36, v6, v4
  v_mul_f32 v37, v6, v5
  v_mul_f32 v46, v10, v8
  v_mul_f32 v47, v10, v9
  v_fma_f32 v34, -v7, v5, v36
  v_fma_f32 v35, v7, v4, v37
  v_fma_f32 v44, -v11, v9, v46
  v_fma_f32 v45, v11, v8, v47
  v_cvt_pk_bf16_f32 v99, v34, v35
  v_cvt_pk_bf16_f32 v141, v44, v45
  v_mul_f32 v36, v34, v4
  v_mul_f32 v37, v34, v5
  v_mul_f32 v46, v44, v8
  v_mul_f32 v47, v44, v9
  v_fma_f32 v6, -v35, v5, v36
  v_fma_f32 v7, v35, v4, v37
  v_fma_f32 v10, -v45, v9, v46
  v_fma_f32 v11, v45, v8, v47
  v_cvt_pk_bf16_f32 v100, v6, v7
  v_cvt_pk_bf16_f32 v142, v10, v11
  v_mul_f32 v36, v6, v4
  v_mul_f32 v37, v6, v5
  v_mul_f32 v46, v10, v8
  v_mul_f32 v47, v10, v9
  v_fma_f32 v34, -v7, v5, v36
  v_fma_f32 v35, v7, v4, v37
  v_fma_f32 v44, -v11, v9, v46
  v_fma_f32 v45, v11, v8, v47
  v_cvt_pk_bf16_f32 v101, v34, v35
  v_cvt_pk_bf16_f32 v143, v44, v45
  v_mul_f32 v36, v34, v4
  v_mul_f32 v37, v34, v5
  v_mul_f32 v46, v44, v8
  v_mul_f32 v47, v44, v9
  v_fma_f32 v6, -v35, v5, v36
  v_fma_f32 v7, v35, v4, v37
  v_fma_f32 v10, -v45, v9, v46
  v_fma_f32 v11, v45, v8, v47
  v_cvt_pk_bf16_f32 v102, v6, v7
  v_cvt_pk_bf16_f32 v144, v10, v11
  v_mul_f32 v36, v6, v4
  v_mul_f32 v37, v6, v5
  v_mul_f32 v46, v10, v8
  v_mul_f32 v47, v10, v9
  v_fma_f32 v34, -v7, v5, v36
  v_fma_f32 v35, v7, v4, v37
  v_fma_f32 v44, -v11, v9, v46
  v_fma_f32 v45, v11, v8, v47
  v_cvt_pk_bf16_f32 v103, v34, v35
  v_cvt_pk_bf16_f32 v145, v44, v45
  v_mul_f32 v36, v34, v4
  v_mul_f32 v37, v34, v5
  v_mul_f32 v46, v44, v8
  v_mul_f32 v47, v44, v9
  v_fma_f32 v6, -v35, v5, v36
  v_fma_f32 v7, v35, v4, v37
  v_fma_f32 v10, -v45, v9, v46
  v_fma_f32 v11, v45, v8, v47
  v_cvt_pk_bf16_f32 v104, v6, v7
  v_cvt_pk_bf16_f32 v146, v10, v11
  v_cvt_pk_bf16_f32 v148, v14, v15
  v_cvt_pk_bf16_f32 v190, v18, v19
  v_mul_f32 v36, v14, v12
  v_mul_f32 v37, v14, v13
  v_mul_f32 v46, v18, v16
  v_mul_f32 v47, v18, v17
  v_fma_f32 v34, -v15, v13, v36
  v_fma_f32 v35, v15, v12, v37
  v_fma_f32 v44, -v19, v17, v46
  v_fma_f32 v45, v19, v16, v47
  v_cvt_pk_bf16_f32 v149, v34, v35
  v_cvt_pk_bf16_f32 v191, v44, v45
  v_mul_f32 v36, v34, v12
  v_mul_f32 v37, v34, v13
  v_mul_f32 v46, v44, v16
  v_mul_f32 v47, v44, v17
  v_fma_f32 v14, -v35, v13, v36
  v_fma_f32 v15, v35, v12, v37
  v_fma_f32 v18, -v45, v17, v46
  v_fma_f32 v19, v45, v16, v47
  v_cvt_pk_bf16_f32 v150, v14, v15
  v_cvt_pk_bf16_f32 v192, v18, v19
  v_mul_f32 v36, v14, v12
  v_mul_f32 v37, v14, v13
  v_mul_f32 v46, v18, v16
  v_mul_f32 v47, v18, v17
  v_fma_f32 v34, -v15, v13, v36
  v_fma_f32 v35, v15, v12, v37
  v_fma_f32 v44, -v19, v17, v46
  v_fma_f32 v45, v19, v16, v47
  v_cvt_pk_bf16_f32 v151, v34, v35
  v_cvt_pk_bf16_f32 v193, v44, v45
  v_mul_f32 v36, v34, v12
  v_mul_f32 v37, v34, v13
  v_mul_f32 v46, v44, v16
  v_mul_f32 v47, v44, v17
  v_fma_f32 v14, -v35, v13, v36
  v_fma_f32 v15, v35, v12, v37
  v_fma_f32 v18, -v45, v17, v46
  v_fma_f32 v19, v45, v16, v47
  v_cvt_pk_bf16_f32 v152, v14, v15
  v_cvt_pk_bf16_f32 v194, v18, v19
  v_mul_f32 v36, v14, v12
  v_mul_f32 v37, v14, v13
  v_mul_f32 v46, v18, v16
  v_mul_f32 v47, v18, v17
  v_fma_f32 v34, -v15, v13, v36
  v_fma_f32 v35, v15, v12, v37
  v_fma_f32 v44, -v19, v17, v46
  v_fma_f32 v45, v19, v16, v47
  v_cvt_pk_bf16_f32 v153, v34, v35
  v_cvt_pk_bf16_f32 v195, v44, v45
  v_mul_f32 v36, v34, v12
  v_mul_f32 v37, v34, v13
  v_mul_f32 v46, v44, v16
  v_mul_f32 v47, v44, v17
  v_fma_f32 v14, -v35, v13, v36
  v_fma_f32 v15, v35, v12, v37
  v_fma_f32 v18, -v45, v17, v46
  v_fma_f32 v19, v45, v16, v47
  v_cvt_pk_bf16_f32 v154, v14, v15
  v_cvt_pk_bf16_f32 v196, v18, v19
  v_mul_f32 v36, v14, v12
  v_mul_f32 v37, v14, v13
  v_mul_f32 v46, v18, v16
  v_mul_f32 v47, v18, v17
  v_fma_f32 v34, -v15, v13, v36
  v_fma_f32 v35, v15, v12, v37
  v_fma_f32 v44, -v19, v17, v46
  v_fma_f32 v45, v19, v16, v47
  v_cvt_pk_bf16_f32 v155, v34, v35
  v_cvt_pk_bf16_f32 v197, v44, v45
  v_mul_f32 v36, v34, v12
  v_mul_f32 v37, v34, v13
  v_mul_f32 v46, v44, v16
  v_mul_f32 v47, v44, v17
  v_fma_f32 v14, -v35, v13, v36
  v_fma_f32 v15, v35, v12, v37
  v_fma_f32 v18, -v45, v17, v46
  v_fma_f32 v19, v45, v16, v47
  v_cvt_pk_bf16_f32 v156, v14, v15
  v_cvt_pk_bf16_f32 v198, v18, v19
  v_mul_f32 v36, v14, v12
  v_mul_f32 v37, v14, v13
  v_mul_f32 v46, v18, v16
  v_mul_f32 v47, v18, v17
  v_fma_f32 v34, -v15, v13, v36
  v_fma_f32 v35, v15, v12, v37
  v_fma_f32 v44, -v19, v17, v46
  v_fma_f32 v45, v19, v16, v47
  v_cvt_pk_bf16_f32 v157, v34, v35
  v_cvt_pk_bf16_f32 v199, v44, v45
  v_mul_f32 v36, v34, v12
  v_mul_f32 v37, v34, v13
  v_mul_f32 v46, v44, v16
  v_mul_f32 v47, v44, v17
  v_fma_f32 v14, -v35, v13, v36
  v_fma_f32 v15, v35, v12, v37
  v_fma_f32 v18, -v45, v17, v46
  v_fma_f32 v19, v45, v16, v47
  v_cvt_pk_bf16_f32 v158, v14, v15
  v_cvt_pk_bf16_f32 v200, v18, v19
  v_mul_f32 v36, v14, v12
  v_mul_f32 v37, v14, v13
  v_mul_f32 v46, v18, v16
  v_mul_f32 v47, v18, v17
  v_fma_f32 v34, -v15, v13, v36
  v_fma_f32 v35, v15, v12, v37
  v_fma_f32 v44, -v19, v17, v46
  v_fma_f32 v45, v19, v16, v47
  v_cvt_pk_bf16_f32 v159, v34, v35
  v_cvt_pk_bf16_f32 v201, v44, v45
  v_mul_f32 v36, v34, v12
  v_mul_f32 v37, v34, v13
  v_mul_f32 v46, v44, v16
  v_mul_f32 v47, v44, v17
  v_fma_f32 v14, -v35, v13, v36
  v_fma_f32 v15, v35, v12, v37
  v_fma_f32 v18, -v45, v17, v46
  v_fma_f32 v19, v45, v16, v47
  v_cvt_pk_bf16_f32 v160, v14, v15
  v_cvt_pk_bf16_f32 v202, v18, v19
  v_mul_f32 v36, v14, v12
  v_mul_f32 v37, v14, v13
  v_mul_f32 v46, v18, v16
  v_mul_f32 v47, v18, v17
  v_fma_f32 v34, -v15, v13, v36
  v_fma_f32 v35, v15, v12, v37
  v_fma_f32 v44, -v19, v17, v46
  v_fma_f32 v45, v19, v16, v47
  v_cvt_pk_bf16_f32 v161, v34, v35
  v_cvt_pk_bf16_f32 v203, v44, v45
  v_mul_f32 v36, v34, v12
  v_mul_f32 v37, v34, v13
  v_mul_f32 v46, v44, v16
  v_mul_f32 v47, v44, v17
  v_fma_f32 v14, -v35, v13, v36
  v_fma_f32 v15, v35, v12, v37
  v_fma_f32 v18, -v45, v17, v46
  v_fma_f32 v19, v45, v16, v47
  v_cvt_pk_bf16_f32 v162, v14, v15
  v_cvt_pk_bf16_f32 v204, v18, v19
  v_mul_f32 v36, v14, v12
  v_mul_f32 v37, v14, v13
  v_mul_f32 v46, v18, v16
  v_mul_f32 v47, v18, v17
  v_fma_f32 v34, -v15, v13, v36
  v_fma_f32 v35, v15, v12, v37
  v_fma_f32 v44, -v19, v17, v46
  v_fma_f32 v45, v19, v16, v47
  v_cvt_pk_bf16_f32 v163, v34, v35
  v_cvt_pk_bf16_f32 v205, v44, v45
  v_mul_f32 v36, v34, v12
  v_mul_f32 v37, v34, v13
  v_mul_f32 v46, v44, v16
  v_mul_f32 v47, v44, v17
  v_fma_f32 v14, -v35, v13, v36
  v_fma_f32 v15, v35, v12, v37
  v_fma_f32 v18, -v45, v17, v46
  v_fma_f32 v19, v45, v16, v47
  v_cvt_pk_bf16_f32 v164, v14, v15
  v_cvt_pk_bf16_f32 v206, v18, v19
  v_mul_f32 v36, v13, v13
  v_mul_f32 v37, v12, v13
  v_mul_f32 v46, v17, v17
  v_mul_f32 v47, v16, v17
  v_fma_f32 v12, v12, v12, -v36
  v_add_f32 v13, v37, v37
  v_fma_f32 v16, v16, v16, -v46
  v_add_f32 v17, v47, v47
  v_mul_f32 v36, v14, v12
  v_mul_f32 v37, v14, v13
  v_mul_f32 v46, v18, v16
  v_mul_f32 v47, v18, v17
  v_fma_f32 v34, -v15, v13, v36
  v_fma_f32 v35, v15, v12, v37
  v_fma_f32 v44, -v19, v17, v46
  v_fma_f32 v45, v19, v16, v47
  v_cvt_pk_bf16_f32 v165, v34, v35
  v_cvt_pk_bf16_f32 v207, v44, v45
  v_mul_f32 v36, v34, v12
  v_mul_f32 v37, v34, v13
  v_mul_f32 v46, v44, v16
  v_mul_f32 v47, v44, v17
  v_fma_f32 v14, -v35, v13, v36
  v_fma_f32 v15, v35, v12, v37
  v_fma_f32 v18, -v45, v17, v46
  v_fma_f32 v19, v45, v16, v47
  v_cvt_pk_bf16_f32 v166, v14, v15
  v_cvt_pk_bf16_f32 v208, v18, v19
  v_mul_f32 v36, v14, v12
  v_mul_f32 v37, v14, v13
  v_mul_f32 v46, v18, v16
  v_mul_f32 v47, v18, v17
  v_fma_f32 v34, -v15, v13, v36
  v_fma_f32 v35, v15, v12, v37
  v_fma_f32 v44, -v19, v17, v46
  v_fma_f32 v45, v19, v16, v47
  v_cvt_pk_bf16_f32 v167, v34, v35
  v_cvt_pk_bf16_f32 v209, v44, v45
  v_mul_f32 v36, v34, v12
  v_mul_f32 v37, v34, v13
  v_mul_f32 v46, v44, v16
  v_mul_f32 v47, v44, v17
  v_fma_f32 v14, -v35, v13, v36
  v_fma_f32 v15, v35, v12, v37
  v_fma_f32 v18, -v45, v17, v46
  v_fma_f32 v19, v45, v16, v47
  v_cvt_pk_bf16_f32 v168, v14, v15
  v_cvt_pk_bf16_f32 v210, v18, v19
  v_mul_f32 v36, v14, v12
  v_mul_f32 v37, v14, v13
  v_mul_f32 v46, v18, v16
  v_mul_f32 v47, v18, v17
  v_fma_f32 v34, -v15, v13, v36
  v_fma_f32 v35, v15, v12, v37
  v_fma_f32 v44, -v19, v17, v46
  v_fma_f32 v45, v19, v16, v47
  v_cvt_pk_bf16_f32 v169, v34, v35
  v_cvt_pk_bf16_f32 v211, v44, v45
  v_mul_f32 v36, v34, v12
  v_mul_f32 v37, v34, v13
  v_mul_f32 v46, v44, v16
  v_mul_f32 v47, v44, v17
  v_fma_f32 v14, -v35, v13, v36
  v_fma_f32 v15, v35, v12, v37
  v_fma_f32 v18, -v45, v17, v46
  v_fma_f32 v19, v45, v16, v47
  v_cvt_pk_bf16_f32 v170, v14, v15
  v_cvt_pk_bf16_f32 v212, v18, v19
  v_mul_f32 v36, v14, v12
  v_mul_f32 v37, v14, v13
  v_mul_f32 v46, v18, v16
  v_mul_f32 v47, v18, v17
  v_fma_f32 v34, -v15, v13, v36
  v_fma_f32 v35, v15, v12, v37
  v_fma_f32 v44, -v19, v17, v46
  v_fma_f32 v45, v19, v16, v47
  v_cvt_pk_bf16_f32 v171, v34, v35
  v_cvt_pk_bf16_f32 v213, v44, v45
  v_mul_f32 v36, v34, v12
  v_mul_f32 v37, v34, v13
  v_mul_f32 v46, v44, v16
  v_mul_f32 v47, v44, v17
  v_fma_f32 v14, -v35, v13, v36
  v_fma_f32 v15, v35, v12, v37
  v_fma_f32 v18, -v45, v17, v46
  v_fma_f32 v19, v45, v16, v47
  v_cvt_pk_bf16_f32 v172, v14, v15
  v_cvt_pk_bf16_f32 v214, v18, v19
  v_mul_f32 v36, v13, v13
  v_mul_f32 v37, v12, v13
  v_mul_f32 v46, v17, v17
  v_mul_f32 v47, v16, v17
  v_fma_f32 v12, v12, v12, -v36
  v_add_f32 v13, v37, v37
  v_fma_f32 v16, v16, v16, -v46
  v_add_f32 v17, v47, v47
  v_mul_f32 v36, v14, v12
  v_mul_f32 v37, v14, v13
  v_mul_f32 v46, v18, v16
  v_mul_f32 v47, v18, v17
  v_fma_f32 v34, -v15, v13, v36
  v_fma_f32 v35, v15, v12, v37
  v_fma_f32 v44, -v19, v17, v46
  v_fma_f32 v45, v19, v16, v47
  v_cvt_pk_bf16_f32 v173, v34, v35
  v_cvt_pk_bf16_f32 v215, v44, v45
  v_mul_f32 v36, v34, v12
  v_mul_f32 v37, v34, v13
  v_mul_f32 v46, v44, v16
  v_mul_f32 v47, v44, v17
  v_fma_f32 v14, -v35, v13, v36
  v_fma_f32 v15, v35, v12, v37
  v_fma_f32 v18, -v45, v17, v46
  v_fma_f32 v19, v45, v16, v47
  v_cvt_pk_bf16_f32 v174, v14, v15
  v_cvt_pk_bf16_f32 v216, v18, v19
  v_mul_f32 v36, v14, v12
  v_mul_f32 v37, v14, v13
  v_mul_f32 v46, v18, v16
  v_mul_f32 v47, v18, v17
  v_fma_f32 v34, -v15, v13, v36
  v_fma_f32 v35, v15, v12, v37
  v_fma_f32 v44, -v19, v17, v46
  v_fma_f32 v45, v19, v16, v47
  v_cvt_pk_bf16_f32 v175, v34, v35
  v_cvt_pk_bf16_f32 v217, v44, v45
  v_mul_f32 v36, v34, v12
  v_mul_f32 v37, v34, v13
  v_mul_f32 v46, v44, v16
  v_mul_f32 v47, v44, v17
  v_fma_f32 v14, -v35, v13, v36
  v_fma_f32 v15, v35, v12, v37
  v_fma_f32 v18, -v45, v17, v46
  v_fma_f32 v19, v45, v16, v47
  v_cvt_pk_bf16_f32 v176, v14, v15
  v_cvt_pk_bf16_f32 v218, v18, v19
  v_mul_f32 v36, v14, v12
  v_mul_f32 v37, v14, v13
  v_mul_f32 v46, v18, v16
  v_mul_f32 v47, v18, v17
  v_fma_f32 v34, -v15, v13, v36
  v_fma_f32 v35, v15, v12, v37
  v_fma_f32 v44, -v19, v17, v46
  v_fma_f32 v45, v19, v16, v47
  v_cvt_pk_bf16_f32 v177, v34, v35
  v_cvt_pk_bf16_f32 v219, v44, v45
  v_mul_f32 v36, v34, v12
  v_mul_f32 v37, v34, v13
  v_mul_f32 v46, v44, v16
  v_mul_f32 v47, v44, v17
  v_fma_f32 v14, -v35, v13, v36
  v_fma_f32 v15, v35, v12, v37
  v_fma_f32 v18, -v45, v17, v46
  v_fma_f32 v19, v45, v16, v47
  v_cvt_pk_bf16_f32 v178, v14, v15
  v_cvt_pk_bf16_f32 v220, v18, v19
  v_mul_f32 v36, v14, v12
  v_mul_f32 v37, v14, v13
  v_mul_f32 v46, v18, v16
  v_mul_f32 v47, v18, v17
  v_fma_f32 v34, -v15, v13, v36
  v_fma_f32 v35, v15, v12, v37
  v_fma_f32 v44, -v19, v17, v46
  v_fma_f32 v45, v19, v16, v47
  v_cvt_pk_bf16_f32 v179, v34, v35
  v_cvt_pk_bf16_f32 v221, v44, v45
  v_mul_f32 v36, v34, v12
  v_mul_f32 v37, v34, v13
  v_mul_f32 v46, v44, v16
  v_mul_f32 v47, v44, v17
  v_fma_f32 v14, -v35, v13, v36
  v_fma_f32 v15, v35, v12, v37
  v_fma_f32 v18, -v45, v17, v46
  v_fma_f32 v19, v45, v16, v47
  v_cvt_pk_bf16_f32 v180, v14, v15
  v_cvt_pk_bf16_f32 v222, v18, v19
  v_mul_f32 v36, v13, v13
  v_mul_f32 v37, v12, v13
  v_mul_f32 v46, v17, v17
  v_mul_f32 v47, v16, v17
  v_fma_f32 v12, v12, v12, -v36
  v_add_f32 v13, v37, v37
  v_fma_f32 v16, v16, v16, -v46
  v_add_f32 v17, v47, v47
  v_mul_f32 v36, v14, v12
  v_mul_f32 v37, v14, v13
  v_mul_f32 v46, v18, v16
  v_mul_f32 v47, v18, v17
  v_fma_f32 v34, -v15, v13, v36
  v_fma_f32 v35, v15, v12, v37
  v_fma_f32 v44, -v19, v17, v46
  v_fma_f32 v45, v19, v16, v47
  v_cvt_pk_bf16_f32 v181, v34, v35
  v_cvt_pk_bf16_f32 v223, v44, v45
  v_mul_f32 v36, v34, v12
  v_mul_f32 v37, v34, v13
  v_mul_f32 v46, v44, v16
  v_mul_f32 v47, v44, v17
  v_fma_f32 v14, -v35, v13, v36
  v_fma_f32 v15, v35, v12, v37
  v_fma_f32 v18, -v45, v17, v46
  v_fma_f32 v19, v45, v16, v47
  v_cvt_pk_bf16_f32 v182, v14, v15
  v_cvt_pk_bf16_f32 v224, v18, v19
  v_mul_f32 v36, v14, v12
  v_mul_f32 v37, v14, v13
  v_mul_f32 v46, v18, v16
  v_mul_f32 v47, v18, v17
  v_fma_f32 v34, -v15, v13, v36
  v_fma_f32 v35, v15, v12, v37
  v_fma_f32 v44, -v19, v17, v46
  v_fma_f32 v45, v19, v16, v47
  v_cvt_pk_bf16_f32 v183, v34, v35
  v_cvt_pk_bf16_f32 v225, v44, v45
  v_mul_f32 v36, v34, v12
  v_mul_f32 v37, v34, v13
  v_mul_f32 v46, v44, v16
  v_mul_f32 v47, v44, v17
  v_fma_f32 v14, -v35, v13, v36
  v_fma_f32 v15, v35, v12, v37
  v_fma_f32 v18, -v45, v17, v46
  v_fma_f32 v19, v45, v16, v47
  v_cvt_pk_bf16_f32 v184, v14, v15
  v_cvt_pk_bf16_f32 v226, v18, v19
  v_mul_f32 v36, v14, v12
  v_mul_f32 v37, v14, v13
  v_mul_f32 v46, v18, v16
  v_mul_f32 v47, v18, v17
  v_fma_f32 v34, -v15, v13, v36
  v_fma_f32 v35, v15, v12, v37
  v_fma_f32 v44, -v19, v17, v46
  v_fma_f32 v45, v19, v16, v47
  v_cvt_pk_bf16_f32 v185, v34, v35
  v_cvt_pk_bf16_f32 v227, v44, v45
  v_mul_f32 v36, v34, v12
  v_mul_f32 v37, v34, v13
  v_mul_f32 v46, v44, v16
  v_mul_f32 v47, v44, v17
  v_fma_f32 v14, -v35, v13, v36
  v_fma_f32 v15, v35, v12, v37
  v_fma_f32 v18, -v45, v17, v46
  v_fma_f32 v19, v45, v16, v47
  v_cvt_pk_bf16_f32 v186, v14, v15
  v_cvt_pk_bf16_f32 v228, v18, v19
  v_mul_f32 v36, v14, v12
  v_mul_f32 v37, v14, v13
  v_mul_f32 v46, v18, v16
  v_mul_f32 v47, v18, v17
  v_fma_f32 v34, -v15, v13, v36
  v_fma_f32 v35, v15, v12, v37
  v_fma_f32 v44, -v19, v17, v46
  v_fma_f32 v45, v19, v16, v47
  v_cvt_pk_bf16_f32 v187, v34, v35
  v_cvt_pk_bf16_f32 v229, v44, v45
  v_mul_f32 v36, v34, v12
  v_mul_f32 v37, v34, v13
  v_mul_f32 v46, v44, v16
  v_mul_f32 v47, v44, v17
  v_fma_f32 v14, -v35, v13, v36
  v_fma_f32 v15, v35, v12, v37
  v_fma_f32 v18, -v45, v17, v46
  v_fma_f32 v19, v45, v16, v47
  v_cvt_pk_bf16_f32 v188, v14, v15
  v_cvt_pk_bf16_f32 v230, v18, v19
  s_setprio 3
  s_and_b32 s43, s2, 7
  s_lshl_b32 s43, s43, 7
  s_add_u32 s43, s43, 12288
  v_mov_b32 v252, s43
  buffer_load_dword v253, v252, s[4:7], 0 offen sc1
  s_waitcnt vmcnt(0)
  s_mov_b32 s58, 4000
L_kc_non:
  v_readfirstlane_b32 s59, v242
  s_nop 3
  s_cmp_lg_u32 s59, 0
  s_cbranch_scc1 L_kc_non_ok
  s_sub_u32 s58, s58, 1
  s_cmp_eq_u32 s58, 0
  s_cbranch_scc1 L_kc_non_ok
  s_sleep 4
  v_mov_b32 v243, 0
  buffer_load_dword v242, v243, s[28:31], 0 offen sc1
  s_waitcnt vmcnt(0)
  s_branch L_kc_non
L_kc_non_ok:
  s_mov_b32 s58, 4000
L_kc_x:
  v_cmp_eq_u32 vcc, s59, v253
  s_nop 3
  s_cmp_eq_u64 vcc, -1
  s_cbranch_scc1 L_kc_x_ok
  s_sub_u32 s58, s58, 1
  s_cmp_eq_u32 s58, 0
  s_cbranch_scc1 L_kc_x_ok
  s_sleep 8
  buffer_load_dword v253, v252, s[4:7], 0 offen sc1
  s_waitcnt vmcnt(0)
  s_branch L_kc_x
L_kc_x_ok:
  s_setprio 0
  ds_write_addtid_b32 v64 offset:0
  ds_write_addtid_b32 v65 offset:288
  ds_write_addtid_b32 v66 offset:576
  ds_write_addtid_b32 v67 offset:864
  ds_write_addtid_b32 v68 offset:1152
  ds_write_addtid_b32 v69 offset:1440
  ds_write_addtid_b32 v70 offset:1728
  ds_write_addtid_b32 v71 offset:2016
  ds_write_addtid_b32 v72 offset:2304
  ds_write_addtid_b32 v73 offset:2592
  ds_write_addtid_b32 v74 offset:2880
  ds_write_addtid_b32 v75 offset:3168
  ds_write_addtid_b32 v76 offset:3456
  ds_write_addtid_b32 v77 offset:3744
  ds_write_addtid_b32 v78 offset:4032
  ds_write_addtid_b32 v79 offset:4320
  ds_write_addtid_b32 v80 offset:4608
  ds_write_addtid_b32 v81 offset:4896
  ds_write_addtid_b32 v82 offset:5184
  ds_write_addtid_b32 v83 offset:5472
  ds_write_addtid_b32 v84 offset:5760
  ds_write_addtid_b32 v85 offset:6048
  ds_write_addtid_b32 v86 offset:6336
  ds_write_addtid_b32 v87 offset:6624
  ds_write_addtid_b32 v88 offset:6912
  ds_write_addtid_b32 v89 offset:7200
  ds_write_addtid_b32 v90 offset:7488
  ds_write_addtid_b32 v91 offset:7776
  ds_write_addtid_b32 v92 offset:8064
  ds_write_addtid_b32 v93 offset:8352
  ds_write_addtid_b32 v94 offset:8640
  ds_write_addtid_b32 v95 offset:8928
  ds_write_addtid_b32 v96 offset:9216
  ds_write_addtid_b32 v97 offset:9504
  ds_write_addtid_b32 v98 offset:9792
  ds_write_addtid_b32 v99 offset:10080
  ds_write_addtid_b32 v100 offset:10368
  ds_write_addtid_b32 v101 offset:10656
  ds_write_addtid_b32 v102 offset:10944
  ds_write_addtid_b32 v103 offset:11232
  ds_write_addtid_b32 v104 offset:11520
  s_waitcnt lgkmcnt(0)
  ds_read_b128 v[64:67], v26 offset:0
  ds_read_b128 v[68:71], v30 offset:0
  ds_read_b128 v[72:75], v27 offset:0
  ds_read_b128 v[76:79], v31 offset:0
  ds_read_b128 v[80:83], v28 offset:0
  ds_read_b128 v[84:87], v32 offset:0
  ds_read_b128 v[88:91], v29 offset:0
  ds_read_b128 v[92:95], v33 offset:0
  s_waitcnt lgkmcnt(6)
  v_mfma_f32_16x16x32_bf16 v[48:51], v[64:67], v[68:71], 0
  s_waitcnt lgkmcnt(4)
  v_mfma_f32_16x16x32_bf16 v[52:55], v[72:75], v[76:79], 0
  s_waitcnt lgkmcnt(2)
  v_mfma_f32_16x16x32_bf16 v[56:59], v[80:83], v[84:87], 0
  s_waitcnt lgkmcnt(0)
  v_mfma_f32_16x16x32_bf16 v[60:63], v[88:91], v[92:95], 0
  ds_read_b128 v[64:67], v26 offset:64
  ds_read_b128 v[68:71], v30 offset:64
  ds_read_b128 v[72:75], v27 offset:64
  ds_read_b128 v[76:79], v31 offset:64
  ds_read_b128 v[80:83], v28 offset:64
  ds_read_b128 v[84:87], v32 offset:64
  ds_read_b128 v[88:91], v29 offset:64
  ds_read_b128 v[92:95], v33 offset:64
  s_waitcnt lgkmcnt(6)
  v_mfma_f32_16x16x32_bf16 v[48:51], v[64:67], v[68:71], v[48:51]
  s_waitcnt lgkmcnt(4)
  v_mfma_f32_16x16x32_bf16 v[52:55], v[72:75], v[76:79], v[52:55]
  s_waitcnt lgkmcnt(2)
  v_mfma_f32_16x16x32_bf16 v[56:59], v[80:83], v[84:87], v[56:59]
  s_waitcnt lgkmcnt(0)
  v_mfma_f32_16x16x32_bf16 v[60:63], v[88:91], v[92:95], v[60:63]
  ds_write_addtid_b32 v106 offset:0
  ds_write_addtid_b32 v107 offset:288
  ds_write_addtid_b32 v108 offset:576
  ds_write_addtid_b32 v109 offset:864
  ds_write_addtid_b32 v110 offset:1152
  ds_write_addtid_b32 v111 offset:1440
  ds_write_addtid_b32 v112 offset:1728
  ds_write_addtid_b32 v113 offset:2016
  ds_write_addtid_b32 v114 offset:2304
  ds_write_addtid_b32 v115 offset:2592
  ds_write_addtid_b32 v116 offset:2880
  ds_write_addtid_b32 v117 offset:3168
  ds_write_addtid_b32 v118 offset:3456
  ds_write_addtid_b32 v119 offset:3744
  ds_write_addtid_b32 v120 offset:4032
  ds_write_addtid_b32 v121 offset:4320
  ds_write_addtid_b32 v122 offset:4608
  ds_write_addtid_b32 v123 offset:4896
  ds_write_addtid_b32 v124 offset:5184
  ds_write_addtid_b32 v125 offset:5472
  ds_write_addtid_b32 v126 offset:5760
  ds_write_addtid_b32 v127 offset:6048
  ds_write_addtid_b32 v128 offset:6336
  ds_write_addtid_b32 v129 offset:6624
  ds_write_addtid_b32 v130 offset:6912
  ds_write_addtid_b32 v131 offset:7200
  ds_write_addtid_b32 v132 offset:7488
  ds_write_addtid_b32 v133 offset:7776
  ds_write_addtid_b32 v134 offset:8064
  ds_write_addtid_b32 v135 offset:8352
  ds_write_addtid_b32 v136 offset:8640
  ds_write_addtid_b32 v137 offset:8928
  ds_write_addtid_b32 v138 offset:9216
  ds_write_addtid_b32 v139 offset:9504
  ds_write_addtid_b32 v140 offset:9792
  ds_write_addtid_b32 v141 offset:10080
  ds_write_addtid_b32 v142 offset:10368
  ds_write_addtid_b32 v143 offset:10656
  ds_write_addtid_b32 v144 offset:10944
  ds_write_addtid_b32 v145 offset:11232
  ds_write_addtid_b32 v146 offset:11520
  s_waitcnt lgkmcnt(0)
  ds_read_b128 v[106:109], v26 offset:0
  ds_read_b128 v[110:113], v30 offset:0
  ds_read_b128 v[114:117], v27 offset:0
  ds_read_b128 v[118:121], v31 offset:0
  ds_read_b128 v[122:125], v28 offset:0
  ds_read_b128 v[126:129], v32 offset:0
  ds_read_b128 v[130:133], v29 offset:0
  ds_read_b128 v[134:137], v33 offset:0
  s_waitcnt lgkmcnt(6)
  v_mfma_f32_16x16x32_bf16 v[48:51], v[106:109], v[110:113], v[48:51]
  s_waitcnt lgkmcnt(4)
  v_mfma_f32_16x16x32_bf16 v[52:55], v[114:117], v[118:121], v[52:55]
  s_waitcnt lgkmcnt(2)
  v_mfma_f32_16x16x32_bf16 v[56:59], v[122:125], v[126:129], v[56:59]
  s_waitcnt lgkmcnt(0)
  v_mfma_f32_16x16x32_bf16 v[60:63], v[130:133], v[134:137], v[60:63]
  ds_read_b128 v[106:109], v26 offset:64
  ds_read_b128 v[110:113], v30 offset:64
  ds_read_b128 v[114:117], v27 offset:64
  ds_read_b128 v[118:121], v31 offset:64
  ds_read_b128 v[122:125], v28 offset:64
  ds_read_b128 v[126:129], v32 offset:64
  ds_read_b128 v[130:133], v29 offset:64
  ds_read_b128 v[134:137], v33 offset:64
  s_waitcnt lgkmcnt(6)
  v_mfma_f32_16x16x32_bf16 v[48:51], v[106:109], v[110:113], v[48:51]
  s_waitcnt lgkmcnt(4)
  v_mfma_f32_16x16x32_bf16 v[52:55], v[114:117], v[118:121], v[52:55]
  s_waitcnt lgkmcnt(2)
  v_mfma_f32_16x16x32_bf16 v[56:59], v[122:125], v[126:129], v[56:59]
  s_waitcnt lgkmcnt(0)
  v_mfma_f32_16x16x32_bf16 v[60:63], v[130:133], v[134:137], v[60:63]
  ds_write_addtid_b32 v148 offset:0
  ds_write_addtid_b32 v149 offset:288
  ds_write_addtid_b32 v150 offset:576
  ds_write_addtid_b32 v151 offset:864
  ds_write_addtid_b32 v152 offset:1152
  ds_write_addtid_b32 v153 offset:1440
  ds_write_addtid_b32 v154 offset:1728
  ds_write_addtid_b32 v155 offset:2016
  ds_write_addtid_b32 v156 offset:2304
  ds_write_addtid_b32 v157 offset:2592
  ds_write_addtid_b32 v158 offset:2880
  ds_write_addtid_b32 v159 offset:3168
  ds_write_addtid_b32 v160 offset:3456
  ds_write_addtid_b32 v161 offset:3744
  ds_write_addtid_b32 v162 offset:4032
  ds_write_addtid_b32 v163 offset:4320
  ds_write_addtid_b32 v164 offset:4608
  ds_write_addtid_b32 v165 offset:4896
  ds_write_addtid_b32 v166 offset:5184
  ds_write_addtid_b32 v167 offset:5472
  ds_write_addtid_b32 v168 offset:5760
  ds_write_addtid_b32 v169 offset:6048
  ds_write_addtid_b32 v170 offset:6336
  ds_write_addtid_b32 v171 offset:6624
  ds_write_addtid_b32 v172 offset:6912
  ds_write_addtid_b32 v173 offset:7200
  ds_write_addtid_b32 v174 offset:7488
  ds_write_addtid_b32 v175 offset:7776
  ds_write_addtid_b32 v176 offset:8064
  ds_write_addtid_b32 v177 offset:8352
  ds_write_addtid_b32 v178 offset:8640
  ds_write_addtid_b32 v179 offset:8928
  ds_write_addtid_b32 v180 offset:9216
  ds_write_addtid_b32 v181 offset:9504
  ds_write_addtid_b32 v182 offset:9792
  ds_write_addtid_b32 v183 offset:10080
  ds_write_addtid_b32 v184 offset:10368
  ds_write_addtid_b32 v185 offset:10656
  ds_write_addtid_b32 v186 offset:10944
  ds_write_addtid_b32 v187 offset:11232
  ds_write_addtid_b32 v188 offset:11520
  s_waitcnt lgkmcnt(0)
  ds_read_b128 v[148:151], v26 offset:0
  ds_read_b128 v[152:155], v30 offset:0
  ds_read_b128 v[156:159], v27 offset:0
  ds_read_b128 v[160:163], v31 offset:0
  ds_read_b128 v[164:167], v28 offset:0
  ds_read_b128 v[168:171], v32 offset:0
  ds_read_b128 v[172:175], v29 offset:0
  ds_read_b128 v[176:179], v33 offset:0
  s_waitcnt lgkmcnt(6)
  v_mfma_f32_16x16x32_bf16 v[48:51], v[148:151], v[152:155], v[48:51]
  s_waitcnt lgkmcnt(4)
  v_mfma_f32_16x16x32_bf16 v[52:55], v[156:159], v[160:163], v[52:55]
  s_waitcnt lgkmcnt(2)
  v_mfma_f32_16x16x32_bf16 v[56:59], v[164:167], v[168:171], v[56:59]
  s_waitcnt lgkmcnt(0)
  v_mfma_f32_16x16x32_bf16 v[60:63], v[172:175], v[176:179], v[60:63]
  ds_read_b128 v[148:151], v26 offset:64
  ds_read_b128 v[152:155], v30 offset:64
  ds_read_b128 v[156:159], v27 offset:64
  ds_read_b128 v[160:163], v31 offset:64
  ds_read_b128 v[164:167], v28 offset:64
  ds_read_b128 v[168:171], v32 offset:64
  ds_read_b128 v[172:175], v29 offset:64
  ds_read_b128 v[176:179], v33 offset:64
  s_waitcnt lgkmcnt(6)
  v_mfma_f32_16x16x32_bf16 v[48:51], v[148:151], v[152:155], v[48:51]
  s_waitcnt lgkmcnt(4)
  v_mfma_f32_16x16x32_bf16 v[52:55], v[156:159], v[160:163], v[52:55]
  s_waitcnt lgkmcnt(2)
  v_mfma_f32_16x16x32_bf16 v[56:59], v[164:167], v[168:171], v[56:59]
  s_waitcnt lgkmcnt(0)
  v_mfma_f32_16x16x32_bf16 v[60:63], v[172:175], v[176:179], v[60:63]
  ds_write_addtid_b32 v190 offset:0
  ds_write_addtid_b32 v191 offset:288
  ds_write_addtid_b32 v192 offset:576
  ds_write_addtid_b32 v193 offset:864
  ds_write_addtid_b32 v194 offset:1152
  ds_write_addtid_b32 v195 offset:1440
  ds_write_addtid_b32 v196 offset:1728
  ds_write_addtid_b32 v197 offset:2016
  ds_write_addtid_b32 v198 offset:2304
  ds_write_addtid_b32 v199 offset:2592
  ds_write_addtid_b32 v200 offset:2880
  ds_write_addtid_b32 v201 offset:3168
  ds_write_addtid_b32 v202 offset:3456
  ds_write_addtid_b32 v203 offset:3744
  ds_write_addtid_b32 v204 offset:4032
  ds_write_addtid_b32 v205 offset:4320
  ds_write_addtid_b32 v206 offset:4608
  ds_write_addtid_b32 v207 offset:4896
  ds_write_addtid_b32 v208 offset:5184
  ds_write_addtid_b32 v209 offset:5472
  ds_write_addtid_b32 v210 offset:5760
  ds_write_addtid_b32 v211 offset:6048
  ds_write_addtid_b32 v212 offset:6336
  ds_write_addtid_b32 v213 offset:6624
  ds_write_addtid_b32 v214 offset:6912
  ds_write_addtid_b32 v215 offset:7200
  ds_write_addtid_b32 v216 offset:7488
  ds_write_addtid_b32 v217 offset:7776
  ds_write_addtid_b32 v218 offset:8064
  ds_write_addtid_b32 v219 offset:8352
  ds_write_addtid_b32 v220 offset:8640
  ds_write_addtid_b32 v221 offset:8928
  ds_write_addtid_b32 v222 offset:9216
  ds_write_addtid_b32 v223 offset:9504
  ds_write_addtid_b32 v224 offset:9792
  ds_write_addtid_b32 v225 offset:10080
  ds_write_addtid_b32 v226 offset:10368
  ds_write_addtid_b32 v227 offset:10656
  ds_write_addtid_b32 v228 offset:10944
  ds_write_addtid_b32 v229 offset:11232
  ds_write_addtid_b32 v230 offset:11520
  s_waitcnt lgkmcnt(0)
  ds_read_b128 v[190:193], v26 offset:0
  ds_read_b128 v[194:197], v30 offset:0
  ds_read_b128 v[198:201], v27 offset:0
  ds_read_b128 v[202:205], v31 offset:0
  ds_read_b128 v[206:209], v28 offset:0
  ds_read_b128 v[210:213], v32 offset:0
  ds_read_b128 v[214:217], v29 offset:0
  ds_read_b128 v[218:221], v33 offset:0
  s_waitcnt lgkmcnt(6)
  v_mfma_f32_16x16x32_bf16 v[48:51], v[190:193], v[194:197], v[48:51]
  s_waitcnt lgkmcnt(4)
  v_mfma_f32_16x16x32_bf16 v[52:55], v[198:201], v[202:205], v[52:55]
  s_waitcnt lgkmcnt(2)
  v_mfma_f32_16x16x32_bf16 v[56:59], v[206:209], v[210:213], v[56:59]
  s_waitcnt lgkmcnt(0)
  v_mfma_f32_16x16x32_bf16 v[60:63], v[214:217], v[218:221], v[60:63]
  ds_read_b128 v[190:193], v26 offset:64
  ds_read_b128 v[194:197], v30 offset:64
  ds_read_b128 v[198:201], v27 offset:64
  ds_read_b128 v[202:205], v31 offset:64
  ds_read_b128 v[206:209], v28 offset:64
  ds_read_b128 v[210:213], v32 offset:64
  ds_read_b128 v[214:217], v29 offset:64
  ds_read_b128 v[218:221], v33 offset:64
  s_waitcnt lgkmcnt(6)
  v_mfma_f32_16x16x32_bf16 v[48:51], v[190:193], v[194:197], v[48:51]
  s_waitcnt lgkmcnt(4)
  v_mfma_f32_16x16x32_bf16 v[52:55], v[198:201], v[202:205], v[52:55]
  s_waitcnt lgkmcnt(2)
  v_mfma_f32_16x16x32_bf16 v[56:59], v[206:209], v[210:213], v[56:59]
  s_waitcnt lgkmcnt(0)
  v_mfma_f32_16x16x32_bf16 v[60:63], v[214:217], v[218:221], v[60:63]
  s_add_u32 s8, s92, 7340032
  s_addc_u32 s9, s93, 0
  s_mov_b32 s10, 2621440
  s_mov_b32 s11, 0x00020000
  s_setprio 3
  v_lshrrev_b32 v46, 2, v2
  v_mul_u32_u24 v46, 40960, v46
  v_and_b32 v47, 3, v2
  v_lshl_add_u32 v46, v47, 4, v46
  s_lshl_b32 s40, s61, 6
  s_add_u32 m0, s33, 512
  s_add_u32 s41, s40, 0
  buffer_load_dwordx4 v46, s[8:11], s41 offen sc1 lds
  s_add_u32 m0, s33, 1536
  s_add_u32 s41, s40, 655360
  buffer_load_dwordx4 v46, s[8:11], s41 offen sc1 lds
  s_add_u32 m0, s33, 2560
  s_add_u32 s41, s40, 1310720
  buffer_load_dwordx4 v46, s[8:11], s41 offen sc1 lds
  s_add_u32 m0, s33, 3584
  s_add_u32 s41, s40, 1966080
  buffer_load_dwordx4 v46, s[8:11], s41 offen sc1 lds
  s_setprio 0
  v_and_b32 v38, 15, v2
  v_lshrrev_b32 v39, 4, v2
  v_lshlrev_b32 v39, 7, v39
  v_lshl_add_u32 v39, v38, 1, v39
  s_add_u32 s41, s33, 11808
  v_add_u32 v39, s41, v39
  v_lshlrev_b32 v66, 1, v2
  v_sub_u32 v66, 2047, v66
  v_cvt_f32_u32 v64, v66
  v_add_f32 v65, -1.0, v64
  v_mov_b32 v68, 0xc3000000
  s_sub_u32 s42, s41, 34048
  v_mov_b32 v70, s42
  v_cvt_pk_bf16_f32 v40, v48, v49
  v_cvt_pk_bf16_f32 v41, v50, v51
  ds_write_b16 v39, v40 offset:0
  ds_write_b16_d16_hi v39, v40 offset:32
  ds_write_b16 v39, v41 offset:64
  ds_write_b16_d16_hi v39, v41 offset:96
  v_cvt_pk_bf16_f32 v40, v52, v53
  v_cvt_pk_bf16_f32 v41, v54, v55
  ds_write_b16 v39, v40 offset:512
  ds_write_b16_d16_hi v39, v40 offset:544
  ds_write_b16 v39, v41 offset:576
  ds_write_b16_d16_hi v39, v41 offset:608
  v_cvt_pk_bf16_f32 v40, v56, v57
  v_cvt_pk_bf16_f32 v41, v58, v59
  ds_write_b16 v39, v40 offset:768
  ds_write_b16_d16_hi v39, v40 offset:800
  ds_write_b16 v39, v41 offset:832
  ds_write_b16_d16_hi v39, v41 offset:864
  v_cvt_pk_bf16_f32 v40, v60, v61
  v_cvt_pk_bf16_f32 v41, v62, v63
  ds_write_b16 v39, v40 offset:1024
  ds_write_b16_d16_hi v39, v40 offset:1056
  ds_write_b16 v39, v41 offset:1088
  ds_write_b16_d16_hi v39, v41 offset:1120
  v_cvt_pk_bf16_f32 v72, v64, v65
  v_add_f32 v64, v68, v64
  v_add_f32 v65, v68, v65
  v_mad_u32_u16 v74, v72, 2, v70 op_sel:[0,0,0,0]
  v_mad_u32_u16 v75, v72, 2, v70 op_sel:[1,0,0,0]
  ds_read_u16 v96, v74
  ds_read_u16 v112, v75
  v_cvt_pk_bf16_f32 v73, v64, v65
  v_add_f32 v64, v68, v64
  v_add_f32 v65, v68, v65
  v_mad_u32_u16 v76, v73, 2, v70 op_sel:[0,0,0,0]
  v_mad_u32_u16 v77, v73, 2, v70 op_sel:[1,0,0,0]
  ds_read_u16 v97, v76
  ds_read_u16 v113, v77
  v_cvt_pk_bf16_f32 v72, v64, v65
  v_add_f32 v64, v68, v64
  v_add_f32 v65, v68, v65
  v_mad_u32_u16 v74, v72, 2, v70 op_sel:[0,0,0,0]
  v_mad_u32_u16 v75, v72, 2, v70 op_sel:[1,0,0,0]
  ds_read_u16 v98, v74
  ds_read_u16 v114, v75
  v_cvt_pk_bf16_f32 v73, v64, v65
  v_add_f32 v64, v68, v64
  v_add_f32 v65, v68, v65
  v_mad_u32_u16 v76, v73, 2, v70 op_sel:[0,0,0,0]
  v_mad_u32_u16 v77, v73, 2, v70 op_sel:[1,0,0,0]
  ds_read_u16 v99, v76
  ds_read_u16 v115, v77
  v_cvt_pk_bf16_f32 v72, v64, v65
  v_add_f32 v64, v68, v64
  v_add_f32 v65, v68, v65
  v_mad_u32_u16 v74, v72, 2, v70 op_sel:[0,0,0,0]
  v_mad_u32_u16 v75, v72, 2, v70 op_sel:[1,0,0,0]
  ds_read_u16 v100, v74
  ds_read_u16 v116, v75
  v_cvt_pk_bf16_f32 v73, v64, v65
  v_add_f32 v64, v68, v64
  v_add_f32 v65, v68, v65
  v_mad_u32_u16 v76, v73, 2, v70 op_sel:[0,0,0,0]
  v_mad_u32_u16 v77, v73, 2, v70 op_sel:[1,0,0,0]
  ds_read_u16 v101, v76
  ds_read_u16 v117, v77
  v_cvt_pk_bf16_f32 v72, v64, v65
  v_add_f32 v64, v68, v64
  v_add_f32 v65, v68, v65
  v_mad_u32_u16 v74, v72, 2, v70 op_sel:[0,0,0,0]
  v_mad_u32_u16 v75, v72, 2, v70 op_sel:[1,0,0,0]
  ds_read_u16 v102, v74
  ds_read_u16 v118, v75
  v_cvt_pk_bf16_f32 v73, v64, v65
  v_add_f32 v64, v68, v64
  v_add_f32 v65, v68, v65
  v_mad_u32_u16 v76, v73, 2, v70 op_sel:[0,0,0,0]
  v_mad_u32_u16 v77, v73, 2, v70 op_sel:[1,0,0,0]
  ds_read_u16 v103, v76
  ds_read_u16 v119, v77
  v_cvt_pk_bf16_f32 v72, v64, v65
  v_add_f32 v64, v68, v64
  v_add_f32 v65, v68, v65
  v_mad_u32_u16 v74, v72, 2, v70 op_sel:[0,0,0,0]
  v_mad_u32_u16 v75, v72, 2, v70 op_sel:[1,0,0,0]
  ds_read_u16 v104, v74
  ds_read_u16 v120, v75
  v_cvt_pk_bf16_f32 v73, v64, v65
  v_add_f32 v64, v68, v64
  v_add_f32 v65, v68, v65
  v_mad_u32_u16 v76, v73, 2, v70 op_sel:[0,0,0,0]
  v_mad_u32_u16 v77, v73, 2, v70 op_sel:[1,0,0,0]
  ds_read_u16 v105, v76
  ds_read_u16 v121, v77
  v_cvt_pk_bf16_f32 v72, v64, v65
  v_add_f32 v64, v68, v64
  v_add_f32 v65, v68, v65
  v_mad_u32_u16 v74, v72, 2, v70 op_sel:[0,0,0,0]
  v_mad_u32_u16 v75, v72, 2, v70 op_sel:[1,0,0,0]
  ds_read_u16 v106, v74
  ds_read_u16 v122, v75
  v_cvt_pk_bf16_f32 v73, v64, v65
  v_add_f32 v64, v68, v64
  v_add_f32 v65, v68, v65
  v_mad_u32_u16 v76, v73, 2, v70 op_sel:[0,0,0,0]
  v_mad_u32_u16 v77, v73, 2, v70 op_sel:[1,0,0,0]
  ds_read_u16 v107, v76
  ds_read_u16 v123, v77
  v_cvt_pk_bf16_f32 v72, v64, v65
  v_add_f32 v64, v68, v64
  v_add_f32 v65, v68, v65
  v_mad_u32_u16 v74, v72, 2, v70 op_sel:[0,0,0,0]
  v_mad_u32_u16 v75, v72, 2, v70 op_sel:[1,0,0,0]
  ds_read_u16 v108, v74
  ds_read_u16 v124, v75
  v_cvt_pk_bf16_f32 v73, v64, v65
  v_add_f32 v64, v68, v64
  v_add_f32 v65, v68, v65
  v_mad_u32_u16 v76, v73, 2, v70 op_sel:[0,0,0,0]
  v_mad_u32_u16 v77, v73, 2, v70 op_sel:[1,0,0,0]
  ds_read_u16 v109, v76
  ds_read_u16 v125, v77
  v_cvt_pk_bf16_f32 v72, v64, v65
  v_add_f32 v64, v68, v64
  v_add_f32 v65, v68, v65
  v_mad_u32_u16 v74, v72, 2, v70 op_sel:[0,0,0,0]
  v_mad_u32_u16 v75, v72, 2, v70 op_sel:[1,0,0,0]
  ds_read_u16 v110, v74
  ds_read_u16 v126, v75
  v_lshlrev_b32 v74, 2, v2
  v_sub_u32 v74, s41, v74
  ds_read_u16 v111, v74 offset:254
  ds_read_u16 v127, v74 offset:252
  s_add_u32 m0, s33, 4608
  s_waitcnt lgkmcnt(15)
  v_lshl_or_b32 v96, v112, 16, v96
  s_waitcnt lgkmcnt(15)
  v_lshl_or_b32 v97, v113, 16, v97
  s_waitcnt lgkmcnt(15)
  v_lshl_or_b32 v98, v114, 16, v98
  s_waitcnt lgkmcnt(15)
  v_lshl_or_b32 v99, v115, 16, v99
  s_waitcnt lgkmcnt(15)
  v_lshl_or_b32 v100, v116, 16, v100
  s_waitcnt lgkmcnt(15)
  v_lshl_or_b32 v101, v117, 16, v101
  s_waitcnt lgkmcnt(15)
  v_lshl_or_b32 v102, v118, 16, v102
  s_waitcnt lgkmcnt(15)
  v_lshl_or_b32 v103, v119, 16, v103
  s_waitcnt lgkmcnt(14)
  v_lshl_or_b32 v104, v120, 16, v104
  s_waitcnt lgkmcnt(12)
  v_lshl_or_b32 v105, v121, 16, v105
  s_waitcnt lgkmcnt(10)
  v_lshl_or_b32 v106, v122, 16, v106
  s_waitcnt lgkmcnt(8)
  v_lshl_or_b32 v107, v123, 16, v107
  s_waitcnt lgkmcnt(6)
  v_lshl_or_b32 v108, v124, 16, v108
  s_waitcnt lgkmcnt(4)
  v_lshl_or_b32 v109, v125, 16, v109
  s_waitcnt lgkmcnt(2)
  v_lshl_or_b32 v110, v126, 16, v110
  s_waitcnt lgkmcnt(0)
  v_lshl_or_b32 v111, v127, 16, v111
  ds_write_addtid_b32 v96 offset:0
  ds_write_addtid_b32 v97 offset:256
  ds_write_addtid_b32 v98 offset:512
  ds_write_addtid_b32 v99 offset:768
  ds_write_addtid_b32 v100 offset:1024
  ds_write_addtid_b32 v101 offset:1280
  ds_write_addtid_b32 v102 offset:1536
  ds_write_addtid_b32 v103 offset:1792
  ds_write_addtid_b32 v104 offset:2048
  ds_write_addtid_b32 v105 offset:2304
  ds_write_addtid_b32 v106 offset:2560
  ds_write_addtid_b32 v107 offset:2816
  ds_write_addtid_b32 v108 offset:3072
  ds_write_addtid_b32 v109 offset:3328
  ds_write_addtid_b32 v110 offset:3584
  ds_write_addtid_b32 v111 offset:3840
  v_mov_b32 v112, 0
  v_mov_b32 v113, 0
  v_mov_b32 v114, 0
  v_mov_b32 v115, 0
  v_lshlrev_b32 v254, 4, v2
  v_add_u32 v254, s33, v254
  s_mov_b64 exec, 0xf
  ds_write_b128 v254, v[112:115] offset:8704
  s_mov_b64 exec, -1
  s_mov_b32 exec_hi, 0
  ds_write_b128 v254, v[112:115] offset:0
  s_mov_b64 exec, -1
  v_lshlrev_b32 v255, 2, v2
  v_add_u32 v255, s33, v255
  s_waitcnt lgkmcnt(0)
  ds_read_b32 v64, v255 offset:4608
  ds_read_b32 v65, v255 offset:4612
  ds_read_b32 v66, v255 offset:4864
  ds_read_b32 v67, v255 offset:4868
  ds_read_b32 v68, v255 offset:5120
  ds_read_b32 v69, v255 offset:5124
  ds_read_b32 v70, v255 offset:5376
  ds_read_b32 v71, v255 offset:5380
  ds_read_b32 v72, v255 offset:5632
  ds_read_b32 v73, v255 offset:5636
  ds_read_b32 v74, v255 offset:5888
  ds_read_b32 v75, v255 offset:5892
  ds_read_b32 v76, v255 offset:6144
  ds_read_b32 v77, v255 offset:6148
  ds_read_b32 v78, v255 offset:6400
  ds_read_b32 v79, v255 offset:6404
  ds_read_b32 v80, v255 offset:6656
  ds_read_b32 v81, v255 offset:6660
  ds_read_b32 v82, v255 offset:6912
  ds_read_b32 v83, v255 offset:6916
  ds_read_b32 v84, v255 offset:7168
  ds_read_b32 v85, v255 offset:7172
  ds_read_b32 v86, v255 offset:7424
  ds_read_b32 v87, v255 offset:7428
  ds_read_b32 v88, v255 offset:7680
  ds_read_b32 v89, v255 offset:7684
  ds_read_b32 v90, v255 offset:7936
  ds_read_b32 v91, v255 offset:7940
  ds_read_b32 v92, v255 offset:8192
  ds_read_b32 v93, v255 offset:8196
  ds_read_b32 v94, v255 offset:8448
  ds_read_b32 v95, v255 offset:8452
  ds_read_b32 v96, v255 offset:8704
  ds_read_b32 v97, v255 offset:8708
  s_add_u32 m0, s33, 8768
  s_waitcnt lgkmcnt(15)
  v_alignbit_b32 v64, v65, v64, 16
  s_waitcnt lgkmcnt(15)
  v_alignbit_b32 v66, v67, v66, 16
  s_waitcnt lgkmcnt(15)
  v_alignbit_b32 v68, v69, v68, 16
  s_waitcnt lgkmcnt(15)
  v_alignbit_b32 v70, v71, v70, 16
  s_waitcnt lgkmcnt(15)
  v_alignbit_b32 v72, v73, v72, 16
  s_waitcnt lgkmcnt(15)
  v_alignbit_b32 v74, v75, v74, 16
  s_waitcnt lgkmcnt(15)
  v_alignbit_b32 v76, v77, v76, 16
  s_waitcnt lgkmcnt(15)
  v_alignbit_b32 v78, v79, v78, 16
  s_waitcnt lgkmcnt(15)
  v_alignbit_b32 v80, v81, v80, 16
  s_waitcnt lgkmcnt(14)
  v_alignbit_b32 v82, v83, v82, 16
  s_waitcnt lgkmcnt(12)
  v_alignbit_b32 v84, v85, v84, 16
  s_waitcnt lgkmcnt(10)
  v_alignbit_b32 v86, v87, v86, 16
  s_waitcnt lgkmcnt(8)
  v_alignbit_b32 v88, v89, v88, 16
  s_waitcnt lgkmcnt(6)
  v_alignbit_b32 v90, v91, v90, 16
  s_waitcnt lgkmcnt(4)
  v_alignbit_b32 v92, v93, v92, 16
  s_waitcnt lgkmcnt(2)
  v_alignbit_b32 v94, v95, v94, 16
  s_waitcnt lgkmcnt(0)
  v_alignbit_b32 v96, v97, v96, 16
  ds_write_addtid_b32 v64 offset:0
  ds_write_addtid_b32 v66 offset:256
  ds_write_addtid_b32 v68 offset:512
  ds_write_addtid_b32 v70 offset:768
  ds_write_addtid_b32 v72 offset:1024
  ds_write_addtid_b32 v74 offset:1280
  ds_write_addtid_b32 v76 offset:1536
  ds_write_addtid_b32 v78 offset:1792
  ds_write_addtid_b32 v80 offset:2048
  ds_write_addtid_b32 v82 offset:2304
  ds_write_addtid_b32 v84 offset:2560
  ds_write_addtid_b32 v86 offset:2816
  ds_write_addtid_b32 v88 offset:3072
  ds_write_addtid_b32 v90 offset:3328
  ds_write_addtid_b32 v92 offset:3584
  ds_write_addtid_b32 v94 offset:3840
  s_mov_b64 exec, 0xffff
  ds_write_addtid_b32 v96 offset:4096
  s_mov_b64 exec, -1
  s_setprio 3
  v_lshlrev_b32 v4, 4, v2
  s_lshl_b32 s40, s61, 12
  s_add_u32 s16, s92, 10485760
  s_addc_u32 s17, s93, 0
  s_mov_b32 s18, 2621440
  s_mov_b32 s19, 0x00020000
  v_and_b32 v10, 15, v2
  v_lshrrev_b32 v11, 4, v2
  v_lshlrev_b32 v5, 5, v10
  v_lshl_add_u32 v5, v11, 4, v5
  s_add_u32 s41, s33, 480
  v_add_u32 v5, s41, v5
  v_and_b32 v172, 1, v10
  v_mov_b32 v173, 8768
  v_mov_b32 v174, 4608
  v_cmp_eq_u32 vcc, 1, v172
  s_nop 1
  v_cndmask_b32 v173, v173, v174, vcc
  v_lshrrev_b32 v172, 1, v10
  v_lshlrev_b32 v172, 2, v172
  v_sub_u32 v173, v173, v172
  v_lshl_add_u32 v173, v11, 4, v173
  s_add_u32 s41, s33, 3548
  v_add_u32 v6, s41, v173
  s_add_u32 s41, s33, 2524
  v_add_u32 v7, s41, v173
  s_add_u32 s41, s33, 1500
  v_add_u32 v8, s41, v173
  s_add_u32 s41, s33, 476
  v_add_u32 v9, s41, v173
  v_lshlrev_b32 v240, 16, v240
  s_waitcnt vmcnt(0) lgkmcnt(0)
  s_setprio 0
  ds_read2_b32 v[44:45], v6 offset0:128 offset1:129
  ds_read2_b32 v[46:47], v6 offset0:130 offset1:131
  ds_read_b128 v[76:79], v5 offset:0
  ds_read2_b32 v[48:49], v6 offset0:0 offset1:1
  ds_read2_b32 v[50:51], v6 offset0:2 offset1:3
  ds_read_b128 v[80:83], v5 offset:512
  ds_read2_b32 v[52:53], v7 offset0:128 offset1:129
  ds_read2_b32 v[54:55], v7 offset0:130 offset1:131
  ds_read_b128 v[84:87], v5 offset:1024
  ds_read2_b32 v[56:57], v7 offset0:0 offset1:1
  ds_read2_b32 v[58:59], v7 offset0:2 offset1:3
  ds_read_b128 v[88:91], v5 offset:1536
  ds_read2_b32 v[60:61], v8 offset0:128 offset1:129
  ds_read2_b32 v[62:63], v8 offset0:130 offset1:131
  ds_read_b128 v[92:95], v5 offset:2048
  ds_read2_b32 v[64:65], v8 offset0:0 offset1:1
  ds_read2_b32 v[66:67], v8 offset0:2 offset1:3
  ds_read_b128 v[96:99], v5 offset:2560
  ds_read2_b32 v[68:69], v9 offset0:128 offset1:129
  ds_read2_b32 v[70:71], v9 offset0:130 offset1:131
  ds_read_b128 v[100:103], v5 offset:3072
  ds_read2_b32 v[72:73], v9 offset0:0 offset1:1
  ds_read2_b32 v[74:75], v9 offset0:2 offset1:3
  ds_read_b128 v[104:107], v5 offset:3584
  v_subrev_u32 v6, 64, v6
  v_subrev_u32 v7, 64, v7
  v_subrev_u32 v8, 64, v8
  v_subrev_u32 v9, 64, v9
  v_subrev_u32 v5, 64, v5
  s_waitcnt lgkmcnt(0)
  v_mfma_f32_16x16x32_bf16 v[12:15], v[44:47], v[76:79], 0
  ds_read2_b32 v[108:109], v6 offset0:128 offset1:129
  v_mfma_f32_16x16x32_bf16 v[16:19], v[44:47], v[80:83], 0
  ds_read2_b32 v[110:111], v6 offset0:130 offset1:131
  v_mfma_f32_16x16x32_bf16 v[20:23], v[44:47], v[84:87], 0
  ds_read_b128 v[140:143], v5 offset:0
  v_mfma_f32_16x16x32_bf16 v[24:27], v[44:47], v[88:91], 0
  ds_read2_b32 v[112:113], v6 offset0:0 offset1:1
  v_mfma_f32_16x16x32_bf16 v[28:31], v[44:47], v[92:95], 0
  ds_read2_b32 v[114:115], v6 offset0:2 offset1:3
  v_mfma_f32_16x16x32_bf16 v[32:35], v[44:47], v[96:99], 0
  ds_read_b128 v[144:147], v5 offset:512
  v_mfma_f32_16x16x32_bf16 v[36:39], v[44:47], v[100:103], 0
  ds_read2_b32 v[116:117], v7 offset0:128 offset1:129
  v_mfma_f32_16x16x32_bf16 v[40:43], v[44:47], v[104:107], 0
  ds_read2_b32 v[118:119], v7 offset0:130 offset1:131
  v_mfma_f32_16x16x32_bf16 v[16:19], v[48:51], v[76:79], v[16:19]
  ds_read_b128 v[148:151], v5 offset:1024
  v_mfma_f32_16x16x32_bf16 v[20:23], v[48:51], v[80:83], v[20:23]
  ds_read2_b32 v[120:121], v7 offset0:0 offset1:1
  v_mfma_f32_16x16x32_bf16 v[24:27], v[48:51], v[84:87], v[24:27]
  ds_read2_b32 v[122:123], v7 offset0:2 offset1:3
  v_mfma_f32_16x16x32_bf16 v[28:31], v[48:51], v[88:91], v[28:31]
  ds_read_b128 v[152:155], v5 offset:1536
  v_mfma_f32_16x16x32_bf16 v[32:35], v[48:51], v[92:95], v[32:35]
  ds_read2_b32 v[124:125], v8 offset0:128 offset1:129
  v_mfma_f32_16x16x32_bf16 v[36:39], v[48:51], v[96:99], v[36:39]
  ds_read2_b32 v[126:127], v8 offset0:130 offset1:131
  v_mfma_f32_16x16x32_bf16 v[40:43], v[48:51], v[100:103], v[40:43]
  ds_read_b128 v[156:159], v5 offset:2048
  v_mfma_f32_16x16x32_bf16 v[20:23], v[52:55], v[76:79], v[20:23]
  ds_read2_b32 v[128:129], v8 offset0:0 offset1:1
  v_mfma_f32_16x16x32_bf16 v[24:27], v[52:55], v[80:83], v[24:27]
  ds_read2_b32 v[130:131], v8 offset0:2 offset1:3
  v_mfma_f32_16x16x32_bf16 v[28:31], v[52:55], v[84:87], v[28:31]
  ds_read_b128 v[160:163], v5 offset:2560
  v_mfma_f32_16x16x32_bf16 v[32:35], v[52:55], v[88:91], v[32:35]
  ds_read2_b32 v[132:133], v9 offset0:128 offset1:129
  v_mfma_f32_16x16x32_bf16 v[36:39], v[52:55], v[92:95], v[36:39]
  ds_read2_b32 v[134:135], v9 offset0:130 offset1:131
  v_mfma_f32_16x16x32_bf16 v[40:43], v[52:55], v[96:99], v[40:43]
  ds_read_b128 v[164:167], v5 offset:3072
  v_mfma_f32_16x16x32_bf16 v[24:27], v[56:59], v[76:79], v[24:27]
  ds_read2_b32 v[136:137], v9 offset0:0 offset1:1
  v_mfma_f32_16x16x32_bf16 v[28:31], v[56:59], v[80:83], v[28:31]
  ds_read2_b32 v[138:139], v9 offset0:2 offset1:3
  v_mfma_f32_16x16x32_bf16 v[32:35], v[56:59], v[84:87], v[32:35]
  ds_read_b128 v[168:171], v5 offset:3584
  v_subrev_u32 v6, 64, v6
  v_subrev_u32 v7, 64, v7
  v_subrev_u32 v8, 64, v8
  v_subrev_u32 v9, 64, v9
  v_subrev_u32 v5, 64, v5
  v_mfma_f32_16x16x32_bf16 v[36:39], v[56:59], v[88:91], v[36:39]
  v_mfma_f32_16x16x32_bf16 v[40:43], v[56:59], v[92:95], v[40:43]
  v_mfma_f32_16x16x32_bf16 v[28:31], v[60:63], v[76:79], v[28:31]
  v_mfma_f32_16x16x32_bf16 v[32:35], v[60:63], v[80:83], v[32:35]
  v_mfma_f32_16x16x32_bf16 v[36:39], v[60:63], v[84:87], v[36:39]
  v_mfma_f32_16x16x32_bf16 v[40:43], v[60:63], v[88:91], v[40:43]
  v_mfma_f32_16x16x32_bf16 v[32:35], v[64:67], v[76:79], v[32:35]
  v_mfma_f32_16x16x32_bf16 v[36:39], v[64:67], v[80:83], v[36:39]
  v_mfma_f32_16x16x32_bf16 v[40:43], v[64:67], v[84:87], v[40:43]
  v_mfma_f32_16x16x32_bf16 v[36:39], v[68:71], v[76:79], v[36:39]
  v_mfma_f32_16x16x32_bf16 v[40:43], v[68:71], v[80:83], v[40:43]
  v_mfma_f32_16x16x32_bf16 v[40:43], v[72:75], v[76:79], v[40:43]
  s_waitcnt lgkmcnt(0)
  v_mfma_f32_16x16x32_bf16 v[12:15], v[108:111], v[140:143], v[12:15]
  ds_read2_b32 v[44:45], v6 offset0:128 offset1:129
  v_mfma_f32_16x16x32_bf16 v[16:19], v[108:111], v[144:147], v[16:19]
  ds_read2_b32 v[46:47], v6 offset0:130 offset1:131
  v_mfma_f32_16x16x32_bf16 v[20:23], v[108:111], v[148:151], v[20:23]
  ds_read_b128 v[76:79], v5 offset:0
  v_mfma_f32_16x16x32_bf16 v[24:27], v[108:111], v[152:155], v[24:27]
  ds_read2_b32 v[48:49], v6 offset0:0 offset1:1
  v_mfma_f32_16x16x32_bf16 v[28:31], v[108:111], v[156:159], v[28:31]
  ds_read2_b32 v[50:51], v6 offset0:2 offset1:3
  v_mfma_f32_16x16x32_bf16 v[32:35], v[108:111], v[160:163], v[32:35]
  ds_read_b128 v[80:83], v5 offset:512
  v_mfma_f32_16x16x32_bf16 v[36:39], v[108:111], v[164:167], v[36:39]
  ds_read2_b32 v[52:53], v7 offset0:128 offset1:129
  v_mfma_f32_16x16x32_bf16 v[40:43], v[108:111], v[168:171], v[40:43]
  ds_read2_b32 v[54:55], v7 offset0:130 offset1:131
  v_mfma_f32_16x16x32_bf16 v[16:19], v[112:115], v[140:143], v[16:19]
  ds_read_b128 v[84:87], v5 offset:1024
  v_mfma_f32_16x16x32_bf16 v[20:23], v[112:115], v[144:147], v[20:23]
  ds_read2_b32 v[56:57], v7 offset0:0 offset1:1
  v_mfma_f32_16x16x32_bf16 v[24:27], v[112:115], v[148:151], v[24:27]
  ds_read2_b32 v[58:59], v7 offset0:2 offset1:3
  v_mfma_f32_16x16x32_bf16 v[28:31], v[112:115], v[152:155], v[28:31]
  ds_read_b128 v[88:91], v5 offset:1536
  v_mfma_f32_16x16x32_bf16 v[32:35], v[112:115], v[156:159], v[32:35]
  ds_read2_b32 v[60:61], v8 offset0:128 offset1:129
  v_mfma_f32_16x16x32_bf16 v[36:39], v[112:115], v[160:163], v[36:39]
  ds_read2_b32 v[62:63], v8 offset0:130 offset1:131
  v_mfma_f32_16x16x32_bf16 v[40:43], v[112:115], v[164:167], v[40:43]
  ds_read_b128 v[92:95], v5 offset:2048
  v_mfma_f32_16x16x32_bf16 v[20:23], v[116:119], v[140:143], v[20:23]
  ds_read2_b32 v[64:65], v8 offset0:0 offset1:1
  v_mfma_f32_16x16x32_bf16 v[24:27], v[116:119], v[144:147], v[24:27]
  ds_read2_b32 v[66:67], v8 offset0:2 offset1:3
  v_mfma_f32_16x16x32_bf16 v[28:31], v[116:119], v[148:151], v[28:31]
  ds_read_b128 v[96:99], v5 offset:2560
  v_mfma_f32_16x16x32_bf16 v[32:35], v[116:119], v[152:155], v[32:35]
  ds_read2_b32 v[68:69], v9 offset0:128 offset1:129
  v_mfma_f32_16x16x32_bf16 v[36:39], v[116:119], v[156:159], v[36:39]
  ds_read2_b32 v[70:71], v9 offset0:130 offset1:131
  v_mfma_f32_16x16x32_bf16 v[40:43], v[116:119], v[160:163], v[40:43]
  ds_read_b128 v[100:103], v5 offset:3072
  v_mfma_f32_16x16x32_bf16 v[24:27], v[120:123], v[140:143], v[24:27]
  ds_read2_b32 v[72:73], v9 offset0:0 offset1:1
  v_mfma_f32_16x16x32_bf16 v[28:31], v[120:123], v[144:147], v[28:31]
  ds_read2_b32 v[74:75], v9 offset0:2 offset1:3
  v_mfma_f32_16x16x32_bf16 v[32:35], v[120:123], v[148:151], v[32:35]
  ds_read_b128 v[104:107], v5 offset:3584
  v_subrev_u32 v6, 64, v6
  v_subrev_u32 v7, 64, v7
  v_subrev_u32 v8, 64, v8
  v_subrev_u32 v9, 64, v9
  v_subrev_u32 v5, 64, v5
  v_mfma_f32_16x16x32_bf16 v[36:39], v[120:123], v[152:155], v[36:39]
  v_mfma_f32_16x16x32_bf16 v[40:43], v[120:123], v[156:159], v[40:43]
  v_mfma_f32_16x16x32_bf16 v[28:31], v[124:127], v[140:143], v[28:31]
  v_mfma_f32_16x16x32_bf16 v[32:35], v[124:127], v[144:147], v[32:35]
  v_mfma_f32_16x16x32_bf16 v[36:39], v[124:127], v[148:151], v[36:39]
  v_mfma_f32_16x16x32_bf16 v[40:43], v[124:127], v[152:155], v[40:43]
  v_mfma_f32_16x16x32_bf16 v[32:35], v[128:131], v[140:143], v[32:35]
  v_mfma_f32_16x16x32_bf16 v[36:39], v[128:131], v[144:147], v[36:39]
  v_mfma_f32_16x16x32_bf16 v[40:43], v[128:131], v[148:151], v[40:43]
  v_mfma_f32_16x16x32_bf16 v[36:39], v[132:135], v[140:143], v[36:39]
  v_mfma_f32_16x16x32_bf16 v[40:43], v[132:135], v[144:147], v[40:43]
  v_mfma_f32_16x16x32_bf16 v[40:43], v[136:139], v[140:143], v[40:43]
  s_waitcnt lgkmcnt(0)
  v_mfma_f32_16x16x32_bf16 v[12:15], v[44:47], v[76:79], v[12:15]
  ds_read2_b32 v[108:109], v6 offset0:128 offset1:129
  v_mfma_f32_16x16x32_bf16 v[16:19], v[44:47], v[80:83], v[16:19]
  ds_read2_b32 v[110:111], v6 offset0:130 offset1:131
  v_mfma_f32_16x16x32_bf16 v[20:23], v[44:47], v[84:87], v[20:23]
  ds_read_b128 v[140:143], v5 offset:0
  v_mfma_f32_16x16x32_bf16 v[24:27], v[44:47], v[88:91], v[24:27]
  ds_read2_b32 v[112:113], v6 offset0:0 offset1:1
  v_mfma_f32_16x16x32_bf16 v[28:31], v[44:47], v[92:95], v[28:31]
  ds_read2_b32 v[114:115], v6 offset0:2 offset1:3
  v_mfma_f32_16x16x32_bf16 v[32:35], v[44:47], v[96:99], v[32:35]
  ds_read_b128 v[144:147], v5 offset:512
  v_mfma_f32_16x16x32_bf16 v[36:39], v[44:47], v[100:103], v[36:39]
  ds_read2_b32 v[116:117], v7 offset0:128 offset1:129
  v_mfma_f32_16x16x32_bf16 v[40:43], v[44:47], v[104:107], v[40:43]
  ds_read2_b32 v[118:119], v7 offset0:130 offset1:131
  v_mfma_f32_16x16x32_bf16 v[16:19], v[48:51], v[76:79], v[16:19]
  ds_read_b128 v[148:151], v5 offset:1024
  v_mfma_f32_16x16x32_bf16 v[20:23], v[48:51], v[80:83], v[20:23]
  ds_read2_b32 v[120:121], v7 offset0:0 offset1:1
  v_mfma_f32_16x16x32_bf16 v[24:27], v[48:51], v[84:87], v[24:27]
  ds_read2_b32 v[122:123], v7 offset0:2 offset1:3
  v_mfma_f32_16x16x32_bf16 v[28:31], v[48:51], v[88:91], v[28:31]
  ds_read_b128 v[152:155], v5 offset:1536
  v_mfma_f32_16x16x32_bf16 v[32:35], v[48:51], v[92:95], v[32:35]
  ds_read2_b32 v[124:125], v8 offset0:128 offset1:129
  v_mfma_f32_16x16x32_bf16 v[36:39], v[48:51], v[96:99], v[36:39]
  ds_read2_b32 v[126:127], v8 offset0:130 offset1:131
  v_mfma_f32_16x16x32_bf16 v[40:43], v[48:51], v[100:103], v[40:43]
  ds_read_b128 v[156:159], v5 offset:2048
  v_mfma_f32_16x16x32_bf16 v[20:23], v[52:55], v[76:79], v[20:23]
  ds_read2_b32 v[128:129], v8 offset0:0 offset1:1
  v_mfma_f32_16x16x32_bf16 v[24:27], v[52:55], v[80:83], v[24:27]
  ds_read2_b32 v[130:131], v8 offset0:2 offset1:3
  v_mfma_f32_16x16x32_bf16 v[28:31], v[52:55], v[84:87], v[28:31]
  ds_read_b128 v[160:163], v5 offset:2560
  v_mfma_f32_16x16x32_bf16 v[32:35], v[52:55], v[88:91], v[32:35]
  ds_read2_b32 v[132:133], v9 offset0:128 offset1:129
  v_mfma_f32_16x16x32_bf16 v[36:39], v[52:55], v[92:95], v[36:39]
  ds_read2_b32 v[134:135], v9 offset0:130 offset1:131
  v_mfma_f32_16x16x32_bf16 v[40:43], v[52:55], v[96:99], v[40:43]
  ds_read_b128 v[164:167], v5 offset:3072
  v_mfma_f32_16x16x32_bf16 v[24:27], v[56:59], v[76:79], v[24:27]
  ds_read2_b32 v[136:137], v9 offset0:0 offset1:1
  v_mfma_f32_16x16x32_bf16 v[28:31], v[56:59], v[80:83], v[28:31]
  ds_read2_b32 v[138:139], v9 offset0:2 offset1:3
  v_mfma_f32_16x16x32_bf16 v[32:35], v[56:59], v[84:87], v[32:35]
  ds_read_b128 v[168:171], v5 offset:3584
  v_subrev_u32 v6, 64, v6
  v_subrev_u32 v7, 64, v7
  v_subrev_u32 v8, 64, v8
  v_subrev_u32 v9, 64, v9
  v_subrev_u32 v5, 64, v5
  v_mfma_f32_16x16x32_bf16 v[36:39], v[56:59], v[88:91], v[36:39]
  v_mfma_f32_16x16x32_bf16 v[40:43], v[56:59], v[92:95], v[40:43]
  v_mfma_f32_16x16x32_bf16 v[28:31], v[60:63], v[76:79], v[28:31]
  v_mfma_f32_16x16x32_bf16 v[32:35], v[60:63], v[80:83], v[32:35]
  v_mfma_f32_16x16x32_bf16 v[36:39], v[60:63], v[84:87], v[36:39]
  v_mfma_f32_16x16x32_bf16 v[40:43], v[60:63], v[88:91], v[40:43]
  v_mfma_f32_16x16x32_bf16 v[32:35], v[64:67], v[76:79], v[32:35]
  v_mfma_f32_16x16x32_bf16 v[36:39], v[64:67], v[80:83], v[36:39]
  v_mfma_f32_16x16x32_bf16 v[40:43], v[64:67], v[84:87], v[40:43]
  v_mfma_f32_16x16x32_bf16 v[36:39], v[68:71], v[76:79], v[36:39]
  v_mfma_f32_16x16x32_bf16 v[40:43], v[68:71], v[80:83], v[40:43]
  v_mfma_f32_16x16x32_bf16 v[40:43], v[72:75], v[76:79], v[40:43]
  s_waitcnt lgkmcnt(0)
  v_mfma_f32_16x16x32_bf16 v[12:15], v[108:111], v[140:143], v[12:15]
  ds_read2_b32 v[44:45], v6 offset0:128 offset1:129
  v_mfma_f32_16x16x32_bf16 v[16:19], v[108:111], v[144:147], v[16:19]
  ds_read2_b32 v[46:47], v6 offset0:130 offset1:131
  v_mfma_f32_16x16x32_bf16 v[20:23], v[108:111], v[148:151], v[20:23]
  ds_read_b128 v[76:79], v5 offset:0
  v_mfma_f32_16x16x32_bf16 v[24:27], v[108:111], v[152:155], v[24:27]
  ds_read2_b32 v[48:49], v6 offset0:0 offset1:1
  v_mfma_f32_16x16x32_bf16 v[28:31], v[108:111], v[156:159], v[28:31]
  ds_read2_b32 v[50:51], v6 offset0:2 offset1:3
  v_mfma_f32_16x16x32_bf16 v[32:35], v[108:111], v[160:163], v[32:35]
  ds_read_b128 v[80:83], v5 offset:512
  v_mfma_f32_16x16x32_bf16 v[36:39], v[108:111], v[164:167], v[36:39]
  ds_read2_b32 v[52:53], v7 offset0:128 offset1:129
  v_mfma_f32_16x16x32_bf16 v[40:43], v[108:111], v[168:171], v[40:43]
  ds_read2_b32 v[54:55], v7 offset0:130 offset1:131
  v_mfma_f32_16x16x32_bf16 v[16:19], v[112:115], v[140:143], v[16:19]
  ds_read_b128 v[84:87], v5 offset:1024
  v_mfma_f32_16x16x32_bf16 v[20:23], v[112:115], v[144:147], v[20:23]
  ds_read2_b32 v[56:57], v7 offset0:0 offset1:1
  v_mfma_f32_16x16x32_bf16 v[24:27], v[112:115], v[148:151], v[24:27]
  ds_read2_b32 v[58:59], v7 offset0:2 offset1:3
  v_mfma_f32_16x16x32_bf16 v[28:31], v[112:115], v[152:155], v[28:31]
  ds_read_b128 v[88:91], v5 offset:1536
  v_mfma_f32_16x16x32_bf16 v[32:35], v[112:115], v[156:159], v[32:35]
  ds_read2_b32 v[60:61], v8 offset0:128 offset1:129
  v_mfma_f32_16x16x32_bf16 v[36:39], v[112:115], v[160:163], v[36:39]
  ds_read2_b32 v[62:63], v8 offset0:130 offset1:131
  v_mfma_f32_16x16x32_bf16 v[40:43], v[112:115], v[164:167], v[40:43]
  ds_read_b128 v[92:95], v5 offset:2048
  v_mfma_f32_16x16x32_bf16 v[20:23], v[116:119], v[140:143], v[20:23]
  ds_read2_b32 v[64:65], v8 offset0:0 offset1:1
  v_mfma_f32_16x16x32_bf16 v[24:27], v[116:119], v[144:147], v[24:27]
  ds_read2_b32 v[66:67], v8 offset0:2 offset1:3
  v_mfma_f32_16x16x32_bf16 v[28:31], v[116:119], v[148:151], v[28:31]
  ds_read_b128 v[96:99], v5 offset:2560
  v_mfma_f32_16x16x32_bf16 v[32:35], v[116:119], v[152:155], v[32:35]
  ds_read2_b32 v[68:69], v9 offset0:128 offset1:129
  v_mfma_f32_16x16x32_bf16 v[36:39], v[116:119], v[156:159], v[36:39]
  ds_read2_b32 v[70:71], v9 offset0:130 offset1:131
  v_mfma_f32_16x16x32_bf16 v[40:43], v[116:119], v[160:163], v[40:43]
  ds_read_b128 v[100:103], v5 offset:3072
  v_mfma_f32_16x16x32_bf16 v[24:27], v[120:123], v[140:143], v[24:27]
  ds_read2_b32 v[72:73], v9 offset0:0 offset1:1
  v_mfma_f32_16x16x32_bf16 v[28:31], v[120:123], v[144:147], v[28:31]
  ds_read2_b32 v[74:75], v9 offset0:2 offset1:3
  v_mfma_f32_16x16x32_bf16 v[32:35], v[120:123], v[148:151], v[32:35]
  ds_read_b128 v[104:107], v5 offset:3584
  v_subrev_u32 v6, 64, v6
  v_subrev_u32 v7, 64, v7
  v_subrev_u32 v8, 64, v8
  v_subrev_u32 v9, 64, v9
  v_subrev_u32 v5, 64, v5
  v_mfma_f32_16x16x32_bf16 v[36:39], v[120:123], v[152:155], v[36:39]
  v_mfma_f32_16x16x32_bf16 v[40:43], v[120:123], v[156:159], v[40:43]
  v_mfma_f32_16x16x32_bf16 v[28:31], v[124:127], v[140:143], v[28:31]
  v_mfma_f32_16x16x32_bf16 v[32:35], v[124:127], v[144:147], v[32:35]
  v_mfma_f32_16x16x32_bf16 v[36:39], v[124:127], v[148:151], v[36:39]
  v_mfma_f32_16x16x32_bf16 v[40:43], v[124:127], v[152:155], v[40:43]
  v_mfma_f32_16x16x32_bf16 v[32:35], v[128:131], v[140:143], v[32:35]
  v_mfma_f32_16x16x32_bf16 v[36:39], v[128:131], v[144:147], v[36:39]
  v_mfma_f32_16x16x32_bf16 v[40:43], v[128:131], v[148:151], v[40:43]
  v_mfma_f32_16x16x32_bf16 v[36:39], v[132:135], v[140:143], v[36:39]
  v_mfma_f32_16x16x32_bf16 v[40:43], v[132:135], v[144:147], v[40:43]
  v_mfma_f32_16x16x32_bf16 v[40:43], v[136:139], v[140:143], v[40:43]
  s_waitcnt lgkmcnt(0)
  v_mfma_f32_16x16x32_bf16 v[12:15], v[44:47], v[76:79], v[12:15]
  ds_read2_b32 v[108:109], v6 offset0:128 offset1:129
  v_mfma_f32_16x16x32_bf16 v[16:19], v[44:47], v[80:83], v[16:19]
  ds_read2_b32 v[110:111], v6 offset0:130 offset1:131
  v_mfma_f32_16x16x32_bf16 v[20:23], v[44:47], v[84:87], v[20:23]
  ds_read_b128 v[140:143], v5 offset:0
  v_mfma_f32_16x16x32_bf16 v[24:27], v[44:47], v[88:91], v[24:27]
  ds_read2_b32 v[112:113], v6 offset0:0 offset1:1
  v_mfma_f32_16x16x32_bf16 v[28:31], v[44:47], v[92:95], v[28:31]
  ds_read2_b32 v[114:115], v6 offset0:2 offset1:3
  v_mfma_f32_16x16x32_bf16 v[32:35], v[44:47], v[96:99], v[32:35]
  ds_read_b128 v[144:147], v5 offset:512
  v_mfma_f32_16x16x32_bf16 v[36:39], v[44:47], v[100:103], v[36:39]
  ds_read2_b32 v[116:117], v7 offset0:128 offset1:129
  v_mfma_f32_16x16x32_bf16 v[40:43], v[44:47], v[104:107], v[40:43]
  ds_read2_b32 v[118:119], v7 offset0:130 offset1:131
  v_mfma_f32_16x16x32_bf16 v[16:19], v[48:51], v[76:79], v[16:19]
  ds_read_b128 v[148:151], v5 offset:1024
  v_mfma_f32_16x16x32_bf16 v[20:23], v[48:51], v[80:83], v[20:23]
  ds_read2_b32 v[120:121], v7 offset0:0 offset1:1
  v_mfma_f32_16x16x32_bf16 v[24:27], v[48:51], v[84:87], v[24:27]
  ds_read2_b32 v[122:123], v7 offset0:2 offset1:3
  v_mfma_f32_16x16x32_bf16 v[28:31], v[48:51], v[88:91], v[28:31]
  ds_read_b128 v[152:155], v5 offset:1536
  v_mfma_f32_16x16x32_bf16 v[32:35], v[48:51], v[92:95], v[32:35]
  ds_read2_b32 v[124:125], v8 offset0:128 offset1:129
  v_mfma_f32_16x16x32_bf16 v[36:39], v[48:51], v[96:99], v[36:39]
  ds_read2_b32 v[126:127], v8 offset0:130 offset1:131
  v_mfma_f32_16x16x32_bf16 v[40:43], v[48:51], v[100:103], v[40:43]
  ds_read_b128 v[156:159], v5 offset:2048
  v_mfma_f32_16x16x32_bf16 v[20:23], v[52:55], v[76:79], v[20:23]
  ds_read2_b32 v[128:129], v8 offset0:0 offset1:1
  v_mfma_f32_16x16x32_bf16 v[24:27], v[52:55], v[80:83], v[24:27]
  ds_read2_b32 v[130:131], v8 offset0:2 offset1:3
  v_mfma_f32_16x16x32_bf16 v[28:31], v[52:55], v[84:87], v[28:31]
  ds_read_b128 v[160:163], v5 offset:2560
  v_mfma_f32_16x16x32_bf16 v[32:35], v[52:55], v[88:91], v[32:35]
  ds_read2_b32 v[132:133], v9 offset0:128 offset1:129
  v_mfma_f32_16x16x32_bf16 v[36:39], v[52:55], v[92:95], v[36:39]
  ds_read2_b32 v[134:135], v9 offset0:130 offset1:131
  v_mfma_f32_16x16x32_bf16 v[40:43], v[52:55], v[96:99], v[40:43]
  ds_read_b128 v[164:167], v5 offset:3072
  v_mfma_f32_16x16x32_bf16 v[24:27], v[56:59], v[76:79], v[24:27]
  ds_read2_b32 v[136:137], v9 offset0:0 offset1:1
  v_mfma_f32_16x16x32_bf16 v[28:31], v[56:59], v[80:83], v[28:31]
  ds_read2_b32 v[138:139], v9 offset0:2 offset1:3
  v_mfma_f32_16x16x32_bf16 v[32:35], v[56:59], v[84:87], v[32:35]
  ds_read_b128 v[168:171], v5 offset:3584
  v_subrev_u32 v6, 64, v6
  v_subrev_u32 v7, 64, v7
  v_subrev_u32 v8, 64, v8
  v_subrev_u32 v9, 64, v9
  v_subrev_u32 v5, 64, v5
  v_mfma_f32_16x16x32_bf16 v[36:39], v[56:59], v[88:91], v[36:39]
  v_mfma_f32_16x16x32_bf16 v[40:43], v[56:59], v[92:95], v[40:43]
  v_mfma_f32_16x16x32_bf16 v[28:31], v[60:63], v[76:79], v[28:31]
  v_mfma_f32_16x16x32_bf16 v[32:35], v[60:63], v[80:83], v[32:35]
  v_mfma_f32_16x16x32_bf16 v[36:39], v[60:63], v[84:87], v[36:39]
  v_mfma_f32_16x16x32_bf16 v[40:43], v[60:63], v[88:91], v[40:43]
  v_mfma_f32_16x16x32_bf16 v[32:35], v[64:67], v[76:79], v[32:35]
  v_mfma_f32_16x16x32_bf16 v[36:39], v[64:67], v[80:83], v[36:39]
  v_mfma_f32_16x16x32_bf16 v[40:43], v[64:67], v[84:87], v[40:43]
  v_mfma_f32_16x16x32_bf16 v[36:39], v[68:71], v[76:79], v[36:39]
  v_mfma_f32_16x16x32_bf16 v[40:43], v[68:71], v[80:83], v[40:43]
  v_mfma_f32_16x16x32_bf16 v[40:43], v[72:75], v[76:79], v[40:43]
  s_waitcnt lgkmcnt(0)
  v_mfma_f32_16x16x32_bf16 v[12:15], v[108:111], v[140:143], v[12:15]
  ds_read2_b32 v[44:45], v6 offset0:128 offset1:129
  v_mfma_f32_16x16x32_bf16 v[16:19], v[108:111], v[144:147], v[16:19]
  ds_read2_b32 v[46:47], v6 offset0:130 offset1:131
  v_mfma_f32_16x16x32_bf16 v[20:23], v[108:111], v[148:151], v[20:23]
  ds_read_b128 v[76:79], v5 offset:0
  v_mfma_f32_16x16x32_bf16 v[24:27], v[108:111], v[152:155], v[24:27]
  ds_read2_b32 v[48:49], v6 offset0:0 offset1:1
  v_mfma_f32_16x16x32_bf16 v[28:31], v[108:111], v[156:159], v[28:31]
  ds_read2_b32 v[50:51], v6 offset0:2 offset1:3
  v_mfma_f32_16x16x32_bf16 v[32:35], v[108:111], v[160:163], v[32:35]
  ds_read_b128 v[80:83], v5 offset:512
  v_mfma_f32_16x16x32_bf16 v[36:39], v[108:111], v[164:167], v[36:39]
  ds_read2_b32 v[52:53], v7 offset0:128 offset1:129
  v_mfma_f32_16x16x32_bf16 v[40:43], v[108:111], v[168:171], v[40:43]
  ds_read2_b32 v[54:55], v7 offset0:130 offset1:131
  v_mfma_f32_16x16x32_bf16 v[16:19], v[112:115], v[140:143], v[16:19]
  ds_read_b128 v[84:87], v5 offset:1024
  v_mfma_f32_16x16x32_bf16 v[20:23], v[112:115], v[144:147], v[20:23]
  ds_read2_b32 v[56:57], v7 offset0:0 offset1:1
  v_mfma_f32_16x16x32_bf16 v[24:27], v[112:115], v[148:151], v[24:27]
  ds_read2_b32 v[58:59], v7 offset0:2 offset1:3
  v_mfma_f32_16x16x32_bf16 v[28:31], v[112:115], v[152:155], v[28:31]
  ds_read_b128 v[88:91], v5 offset:1536
  v_mfma_f32_16x16x32_bf16 v[32:35], v[112:115], v[156:159], v[32:35]
  ds_read2_b32 v[60:61], v8 offset0:128 offset1:129
  v_mfma_f32_16x16x32_bf16 v[36:39], v[112:115], v[160:163], v[36:39]
  ds_read2_b32 v[62:63], v8 offset0:130 offset1:131
  v_mfma_f32_16x16x32_bf16 v[40:43], v[112:115], v[164:167], v[40:43]
  ds_read_b128 v[92:95], v5 offset:2048
  v_mfma_f32_16x16x32_bf16 v[20:23], v[116:119], v[140:143], v[20:23]
  ds_read2_b32 v[64:65], v8 offset0:0 offset1:1
  v_mfma_f32_16x16x32_bf16 v[24:27], v[116:119], v[144:147], v[24:27]
  ds_read2_b32 v[66:67], v8 offset0:2 offset1:3
  v_mfma_f32_16x16x32_bf16 v[28:31], v[116:119], v[148:151], v[28:31]
  ds_read_b128 v[96:99], v5 offset:2560
  v_mfma_f32_16x16x32_bf16 v[32:35], v[116:119], v[152:155], v[32:35]
  ds_read2_b32 v[68:69], v9 offset0:128 offset1:129
  v_mfma_f32_16x16x32_bf16 v[36:39], v[116:119], v[156:159], v[36:39]
  ds_read2_b32 v[70:71], v9 offset0:130 offset1:131
  v_mfma_f32_16x16x32_bf16 v[40:43], v[116:119], v[160:163], v[40:43]
  ds_read_b128 v[100:103], v5 offset:3072
  v_mfma_f32_16x16x32_bf16 v[24:27], v[120:123], v[140:143], v[24:27]
  ds_read2_b32 v[72:73], v9 offset0:0 offset1:1
  v_mfma_f32_16x16x32_bf16 v[28:31], v[120:123], v[144:147], v[28:31]
  ds_read2_b32 v[74:75], v9 offset0:2 offset1:3
  v_mfma_f32_16x16x32_bf16 v[32:35], v[120:123], v[148:151], v[32:35]
  ds_read_b128 v[104:107], v5 offset:3584
  v_subrev_u32 v6, 64, v6
  v_subrev_u32 v7, 64, v7
  v_subrev_u32 v8, 64, v8
  v_subrev_u32 v9, 64, v9
  v_subrev_u32 v5, 64, v5
  v_mfma_f32_16x16x32_bf16 v[36:39], v[120:123], v[152:155], v[36:39]
  v_mfma_f32_16x16x32_bf16 v[40:43], v[120:123], v[156:159], v[40:43]
  v_mfma_f32_16x16x32_bf16 v[28:31], v[124:127], v[140:143], v[28:31]
  v_mfma_f32_16x16x32_bf16 v[32:35], v[124:127], v[144:147], v[32:35]
  v_mfma_f32_16x16x32_bf16 v[36:39], v[124:127], v[148:151], v[36:39]
  v_mfma_f32_16x16x32_bf16 v[40:43], v[124:127], v[152:155], v[40:43]
  v_mfma_f32_16x16x32_bf16 v[32:35], v[128:131], v[140:143], v[32:35]
  v_mfma_f32_16x16x32_bf16 v[36:39], v[128:131], v[144:147], v[36:39]
  v_mfma_f32_16x16x32_bf16 v[40:43], v[128:131], v[148:151], v[40:43]
  v_mfma_f32_16x16x32_bf16 v[36:39], v[132:135], v[140:143], v[36:39]
  v_mfma_f32_16x16x32_bf16 v[40:43], v[132:135], v[144:147], v[40:43]
  v_mfma_f32_16x16x32_bf16 v[40:43], v[136:139], v[140:143], v[40:43]
  s_waitcnt lgkmcnt(0)
  v_mfma_f32_16x16x32_bf16 v[12:15], v[44:47], v[76:79], v[12:15]
  ds_read2_b32 v[108:109], v6 offset0:128 offset1:129
  v_mfma_f32_16x16x32_bf16 v[16:19], v[44:47], v[80:83], v[16:19]
  ds_read2_b32 v[110:111], v6 offset0:130 offset1:131
  v_mfma_f32_16x16x32_bf16 v[20:23], v[44:47], v[84:87], v[20:23]
  ds_read_b128 v[140:143], v5 offset:0
  v_mfma_f32_16x16x32_bf16 v[24:27], v[44:47], v[88:91], v[24:27]
  ds_read2_b32 v[112:113], v6 offset0:0 offset1:1
  v_mfma_f32_16x16x32_bf16 v[28:31], v[44:47], v[92:95], v[28:31]
  ds_read2_b32 v[114:115], v6 offset0:2 offset1:3
  v_mfma_f32_16x16x32_bf16 v[32:35], v[44:47], v[96:99], v[32:35]
  ds_read_b128 v[144:147], v5 offset:512
  v_mfma_f32_16x16x32_bf16 v[36:39], v[44:47], v[100:103], v[36:39]
  ds_read2_b32 v[116:117], v7 offset0:128 offset1:129
  v_mfma_f32_16x16x32_bf16 v[40:43], v[44:47], v[104:107], v[40:43]
  ds_read2_b32 v[118:119], v7 offset0:130 offset1:131
  v_mfma_f32_16x16x32_bf16 v[16:19], v[48:51], v[76:79], v[16:19]
  ds_read_b128 v[148:151], v5 offset:1024
  v_mfma_f32_16x16x32_bf16 v[20:23], v[48:51], v[80:83], v[20:23]
  ds_read2_b32 v[120:121], v7 offset0:0 offset1:1
  v_mfma_f32_16x16x32_bf16 v[24:27], v[48:51], v[84:87], v[24:27]
  ds_read2_b32 v[122:123], v7 offset0:2 offset1:3
  v_mfma_f32_16x16x32_bf16 v[28:31], v[48:51], v[88:91], v[28:31]
  ds_read_b128 v[152:155], v5 offset:1536
  v_mfma_f32_16x16x32_bf16 v[32:35], v[48:51], v[92:95], v[32:35]
  ds_read2_b32 v[124:125], v8 offset0:128 offset1:129
  v_mfma_f32_16x16x32_bf16 v[36:39], v[48:51], v[96:99], v[36:39]
  ds_read2_b32 v[126:127], v8 offset0:130 offset1:131
  v_mfma_f32_16x16x32_bf16 v[40:43], v[48:51], v[100:103], v[40:43]
  ds_read_b128 v[156:159], v5 offset:2048
  v_mfma_f32_16x16x32_bf16 v[20:23], v[52:55], v[76:79], v[20:23]
  ds_read2_b32 v[128:129], v8 offset0:0 offset1:1
  v_mfma_f32_16x16x32_bf16 v[24:27], v[52:55], v[80:83], v[24:27]
  ds_read2_b32 v[130:131], v8 offset0:2 offset1:3
  v_mfma_f32_16x16x32_bf16 v[28:31], v[52:55], v[84:87], v[28:31]
  ds_read_b128 v[160:163], v5 offset:2560
  v_mfma_f32_16x16x32_bf16 v[32:35], v[52:55], v[88:91], v[32:35]
  ds_read2_b32 v[132:133], v9 offset0:128 offset1:129
  v_mfma_f32_16x16x32_bf16 v[36:39], v[52:55], v[92:95], v[36:39]
  ds_read2_b32 v[134:135], v9 offset0:130 offset1:131
  v_mfma_f32_16x16x32_bf16 v[40:43], v[52:55], v[96:99], v[40:43]
  ds_read_b128 v[164:167], v5 offset:3072
  v_mfma_f32_16x16x32_bf16 v[24:27], v[56:59], v[76:79], v[24:27]
  ds_read2_b32 v[136:137], v9 offset0:0 offset1:1
  v_mfma_f32_16x16x32_bf16 v[28:31], v[56:59], v[80:83], v[28:31]
  ds_read2_b32 v[138:139], v9 offset0:2 offset1:3
  v_mfma_f32_16x16x32_bf16 v[32:35], v[56:59], v[84:87], v[32:35]
  ds_read_b128 v[168:171], v5 offset:3584
  v_mfma_f32_16x16x32_bf16 v[36:39], v[56:59], v[88:91], v[36:39]
  v_mfma_f32_16x16x32_bf16 v[40:43], v[56:59], v[92:95], v[40:43]
  v_mfma_f32_16x16x32_bf16 v[28:31], v[60:63], v[76:79], v[28:31]
  v_mfma_f32_16x16x32_bf16 v[32:35], v[60:63], v[80:83], v[32:35]
  v_mfma_f32_16x16x32_bf16 v[36:39], v[60:63], v[84:87], v[36:39]
  v_mfma_f32_16x16x32_bf16 v[40:43], v[60:63], v[88:91], v[40:43]
  v_mfma_f32_16x16x32_bf16 v[32:35], v[64:67], v[76:79], v[32:35]
  v_mfma_f32_16x16x32_bf16 v[36:39], v[64:67], v[80:83], v[36:39]
  v_mfma_f32_16x16x32_bf16 v[40:43], v[64:67], v[84:87], v[40:43]
  v_mfma_f32_16x16x32_bf16 v[36:39], v[68:71], v[76:79], v[36:39]
  v_mfma_f32_16x16x32_bf16 v[40:43], v[68:71], v[80:83], v[40:43]
  v_mfma_f32_16x16x32_bf16 v[40:43], v[72:75], v[76:79], v[40:43]
  s_waitcnt lgkmcnt(0)
  v_mfma_f32_16x16x32_bf16 v[12:15], v[108:111], v[140:143], v[12:15]
  v_mfma_f32_16x16x32_bf16 v[16:19], v[108:111], v[144:147], v[16:19]
  v_mfma_f32_16x16x32_bf16 v[20:23], v[108:111], v[148:151], v[20:23]
  v_mfma_f32_16x16x32_bf16 v[24:27], v[108:111], v[152:155], v[24:27]
  v_mfma_f32_16x16x32_bf16 v[28:31], v[108:111], v[156:159], v[28:31]
  v_mfma_f32_16x16x32_bf16 v[32:35], v[108:111], v[160:163], v[32:35]
  v_mfma_f32_16x16x32_bf16 v[36:39], v[108:111], v[164:167], v[36:39]
  v_mfma_f32_16x16x32_bf16 v[40:43], v[108:111], v[168:171], v[40:43]
  v_mfma_f32_16x16x32_bf16 v[16:19], v[112:115], v[140:143], v[16:19]
  v_mfma_f32_16x16x32_bf16 v[20:23], v[112:115], v[144:147], v[20:23]
  v_mfma_f32_16x16x32_bf16 v[24:27], v[112:115], v[148:151], v[24:27]
  v_mfma_f32_16x16x32_bf16 v[28:31], v[112:115], v[152:155], v[28:31]
  v_mfma_f32_16x16x32_bf16 v[32:35], v[112:115], v[156:159], v[32:35]
  v_mfma_f32_16x16x32_bf16 v[36:39], v[112:115], v[160:163], v[36:39]
  v_mfma_f32_16x16x32_bf16 v[40:43], v[112:115], v[164:167], v[40:43]
  v_mfma_f32_16x16x32_bf16 v[20:23], v[116:119], v[140:143], v[20:23]
  v_mfma_f32_16x16x32_bf16 v[24:27], v[116:119], v[144:147], v[24:27]
  v_mfma_f32_16x16x32_bf16 v[28:31], v[116:119], v[148:151], v[28:31]
  v_mfma_f32_16x16x32_bf16 v[32:35], v[116:119], v[152:155], v[32:35]
  v_mfma_f32_16x16x32_bf16 v[36:39], v[116:119], v[156:159], v[36:39]
  v_mfma_f32_16x16x32_bf16 v[40:43], v[116:119], v[160:163], v[40:43]
  v_mfma_f32_16x16x32_bf16 v[24:27], v[120:123], v[140:143], v[24:27]
  v_mfma_f32_16x16x32_bf16 v[28:31], v[120:123], v[144:147], v[28:31]
  v_mfma_f32_16x16x32_bf16 v[32:35], v[120:123], v[148:151], v[32:35]
  v_mfma_f32_16x16x32_bf16 v[36:39], v[120:123], v[152:155], v[36:39]
  v_mfma_f32_16x16x32_bf16 v[40:43], v[120:123], v[156:159], v[40:43]
  v_mfma_f32_16x16x32_bf16 v[28:31], v[124:127], v[140:143], v[28:31]
  v_mfma_f32_16x16x32_bf16 v[32:35], v[124:127], v[144:147], v[32:35]
  v_mfma_f32_16x16x32_bf16 v[36:39], v[124:127], v[148:151], v[36:39]
  v_mfma_f32_16x16x32_bf16 v[40:43], v[124:127], v[152:155], v[40:43]
  v_mfma_f32_16x16x32_bf16 v[32:35], v[128:131], v[140:143], v[32:35]
  v_mfma_f32_16x16x32_bf16 v[36:39], v[128:131], v[144:147], v[36:39]
  v_mfma_f32_16x16x32_bf16 v[40:43], v[128:131], v[148:151], v[40:43]
  v_mfma_f32_16x16x32_bf16 v[36:39], v[132:135], v[140:143], v[36:39]
  v_mfma_f32_16x16x32_bf16 v[40:43], v[132:135], v[144:147], v[40:43]
  v_mfma_f32_16x16x32_bf16 v[40:43], v[136:139], v[140:143], v[40:43]
  s_setprio 3
  v_lshlrev_b32 v5, 5, v10
  v_lshl_add_u32 v5, v11, 3, v5
  s_add_u32 s41, s33, 512
  v_add_u32 v5, s41, v5
  ds_read_b64 v[44:45], v5 offset:0
  ds_read_b64 v[46:47], v5 offset:512
  ds_read_b64 v[48:49], v5 offset:1024
  ds_read_b64 v[50:51], v5 offset:1536
  ds_read_b64 v[52:53], v5 offset:2048
  ds_read_b64 v[54:55], v5 offset:2560
  ds_read_b64 v[56:57], v5 offset:3072
  ds_read_b64 v[58:59], v5 offset:3584
  s_waitcnt lgkmcnt(7)
  v_lshlrev_b32 v76, 16, v44
  v_and_b32 v77, 0xffff0000, v44
  v_lshlrev_b32 v78, 16, v45
  v_and_b32 v79, 0xffff0000, v45
  v_fmac_f32 v12, v76, v240
  v_fmac_f32 v13, v77, v240
  v_fmac_f32 v14, v78, v240
  v_fmac_f32 v15, v79, v240
  v_cvt_pk_bf16_f32 v44, v12, v13
  v_cvt_pk_bf16_f32 v45, v14, v15
  ds_write_b64 v5, v[44:45] offset:0
  s_waitcnt lgkmcnt(7)
  v_lshlrev_b32 v80, 16, v46
  v_and_b32 v81, 0xffff0000, v46
  v_lshlrev_b32 v82, 16, v47
  v_and_b32 v83, 0xffff0000, v47
  v_fmac_f32 v16, v80, v240
  v_fmac_f32 v17, v81, v240
  v_fmac_f32 v18, v82, v240
  v_fmac_f32 v19, v83, v240
  v_cvt_pk_bf16_f32 v46, v16, v17
  v_cvt_pk_bf16_f32 v47, v18, v19
  ds_write_b64 v5, v[46:47] offset:512
  s_waitcnt lgkmcnt(7)
  v_lshlrev_b32 v76, 16, v48
  v_and_b32 v77, 0xffff0000, v48
  v_lshlrev_b32 v78, 16, v49
  v_and_b32 v79, 0xffff0000, v49
  v_fmac_f32 v20, v76, v240
  v_fmac_f32 v21, v77, v240
  v_fmac_f32 v22, v78, v240
  v_fmac_f32 v23, v79, v240
  v_cvt_pk_bf16_f32 v48, v20, v21
  v_cvt_pk_bf16_f32 v49, v22, v23
  ds_write_b64 v5, v[48:49] offset:1024
  s_waitcnt lgkmcnt(7)
  v_lshlrev_b32 v80, 16, v50
  v_and_b32 v81, 0xffff0000, v50
  v_lshlrev_b32 v82, 16, v51
  v_and_b32 v83, 0xffff0000, v51
  v_fmac_f32 v24, v80, v240
  v_fmac_f32 v25, v81, v240
  v_fmac_f32 v26, v82, v240
  v_fmac_f32 v27, v83, v240
  v_cvt_pk_bf16_f32 v50, v24, v25
  v_cvt_pk_bf16_f32 v51, v26, v27
  ds_write_b64 v5, v[50:51] offset:1536
  s_waitcnt lgkmcnt(7)
  v_lshlrev_b32 v76, 16, v52
  v_and_b32 v77, 0xffff0000, v52
  v_lshlrev_b32 v78, 16, v53
  v_and_b32 v79, 0xffff0000, v53
  v_fmac_f32 v28, v76, v240
  v_fmac_f32 v29, v77, v240
  v_fmac_f32 v30, v78, v240
  v_fmac_f32 v31, v79, v240
  v_cvt_pk_bf16_f32 v52, v28, v29
  v_cvt_pk_bf16_f32 v53, v30, v31
  ds_write_b64 v5, v[52:53] offset:2048
  s_waitcnt lgkmcnt(7)
  v_lshlrev_b32 v80, 16, v54
  v_and_b32 v81, 0xffff0000, v54
  v_lshlrev_b32 v82, 16, v55
  v_and_b32 v83, 0xffff0000, v55
  v_fmac_f32 v32, v80, v240
  v_fmac_f32 v33, v81, v240
  v_fmac_f32 v34, v82, v240
  v_fmac_f32 v35, v83, v240
  v_cvt_pk_bf16_f32 v54, v32, v33
  v_cvt_pk_bf16_f32 v55, v34, v35
  ds_write_b64 v5, v[54:55] offset:2560
  s_waitcnt lgkmcnt(7)
  v_lshlrev_b32 v76, 16, v56
  v_and_b32 v77, 0xffff0000, v56
  v_lshlrev_b32 v78, 16, v57
  v_and_b32 v79, 0xffff0000, v57
  v_fmac_f32 v36, v76, v240
  v_fmac_f32 v37, v77, v240
  v_fmac_f32 v38, v78, v240
  v_fmac_f32 v39, v79, v240
  v_cvt_pk_bf16_f32 v56, v36, v37
  v_cvt_pk_bf16_f32 v57, v38, v39
  ds_write_b64 v5, v[56:57] offset:3072
  s_waitcnt lgkmcnt(7)
  v_lshlrev_b32 v80, 16, v58
  v_and_b32 v81, 0xffff0000, v58
  v_lshlrev_b32 v82, 16, v59
  v_and_b32 v83, 0xffff0000, v59
  v_fmac_f32 v40, v80, v240
  v_fmac_f32 v41, v81, v240
  v_fmac_f32 v42, v82, v240
  v_fmac_f32 v43, v83, v240
  v_cvt_pk_bf16_f32 v58, v40, v41
  v_cvt_pk_bf16_f32 v59, v42, v43
  ds_write_b64 v5, v[58:59] offset:3584
  s_waitcnt lgkmcnt(0)
  ds_read_b128 v[108:111], v254 offset:512
  ds_read_b128 v[112:115], v254 offset:1536
  ds_read_b128 v[116:119], v254 offset:2560
  ds_read_b128 v[120:123], v254 offset:3584
  s_waitcnt lgkmcnt(3)
  buffer_store_dwordx4 v[108:111], v4, s[16:19], s40 offen offset:0 sc1
  s_waitcnt lgkmcnt(2)
  buffer_store_dwordx4 v[112:115], v4, s[16:19], s40 offen offset:1024 sc1
  s_waitcnt lgkmcnt(1)
  buffer_store_dwordx4 v[116:119], v4, s[16:19], s40 offen offset:2048 sc1
  s_waitcnt lgkmcnt(0)
  buffer_store_dwordx4 v[120:123], v4, s[16:19], s40 offen offset:3072 sc1
  s_waitcnt vmcnt(0)
  s_barrier
  s_cmp_lg_u32 s32, 0
  s_cbranch_scc1 L_kc_done
  s_lshl_b32 s45, s60, 7
  s_lshl_b32 s43, s56, 2
  s_add_u32 s43, s43, s45
  s_add_u32 s43, s43, 6656
  v_mov_b32 v172, s43
  v_mov_b32 v173, s59
  s_mov_b64 exec, 1
  buffer_store_dword v173, v172, s[4:7], 0 offen sc1
  s_mov_b64 exec, -1
L_kc_done:
  s_waitcnt vmcnt(0)
  s_endpgm
L_w2f:
  s_cmp_ge_u32 s62, 216
  s_cbranch_scc1 L_exit
  s_mov_b32 s56, 40320
  s_lshr_b32 s33, s62, 2
  s_and_b32 s34, s62, 3
  s_mov_b32 s35, 214748365
  v_add_u32 v3, 0, v2
  v_mul_hi_u32 v4, s35, v3
  v_mul_u32_u24 v5, 20, v4
  v_sub_u32 v5, v3, v5
  v_lshlrev_b32 v5, 4, v5
  v_mul_u32_u24 v4, 1280, v4
  v_add_u32 v8, v4, v5
  v_add_u32 v3, 64, v2
  v_mul_hi_u32 v4, s35, v3
  v_mul_u32_u24 v5, 20, v4
  v_sub_u32 v5, v3, v5
  v_lshlrev_b32 v5, 4, v5
  v_mul_u32_u24 v4, 1280, v4
  v_add_u32 v9, v4, v5
  v_add_u32 v3, 128, v2
  v_mul_hi_u32 v4, s35, v3
  v_mul_u32_u24 v5, 20, v4
  v_sub_u32 v5, v3, v5
  v_lshlrev_b32 v5, 4, v5
  v_mul_u32_u24 v4, 1280, v4
  v_add_u32 v10, v4, v5
  v_add_u32 v3, 192, v2
  v_mul_hi_u32 v4, s35, v3
  v_mul_u32_u24 v5, 20, v4
  v_sub_u32 v5, v3, v5
  v_lshlrev_b32 v5, 4, v5
  v_mul_u32_u24 v4, 1280, v4
  v_add_u32 v11, v4, v5
  v_add_u32 v3, 256, v2
  v_mul_hi_u32 v4, s35, v3
  v_mul_u32_u24 v5, 20, v4
  v_sub_u32 v5, v3, v5
  v_lshlrev_b32 v5, 4, v5
  v_mul_u32_u24 v4, 1280, v4
  v_add_u32 v12, v4, v5
  v_add_u32 v3, 320, v2
  v_mul_hi_u32 v4, s35, v3
  v_mul_u32_u24 v5, 20, v4
  v_sub_u32 v5, v3, v5
  v_lshlrev_b32 v5, 4, v5
  v_mul_u32_u24 v4, 1280, v4
  v_add_u32 v13, v4, v5
  v_add_u32 v3, 384, v2
  v_mul_hi_u32 v4, s35, v3
  v_mul_u32_u24 v5, 20, v4
  v_sub_u32 v5, v3, v5
  v_lshlrev_b32 v5, 4, v5
  v_mul_u32_u24 v4, 1280, v4
  v_add_u32 v14, v4, v5
  v_add_u32 v3, 448, v2
  v_mul_hi_u32 v4, s35, v3
  v_mul_u32_u24 v5, 20, v4
  v_sub_u32 v5, v3, v5
  v_lshlrev_b32 v5, 4, v5
  v_mul_u32_u24 v4, 1280, v4
  v_add_u32 v15, v4, v5
  v_add_u32 v3, 512, v2
  v_mul_hi_u32 v4, s35, v3
  v_mul_u32_u24 v5, 20, v4
  v_sub_u32 v5, v3, v5
  v_lshlrev_b32 v5, 4, v5
  v_mul_u32_u24 v4, 1280, v4
  v_add_u32 v16, v4, v5
  v_add_u32 v3, 576, v2
  v_mul_hi_u32 v4, s35, v3
  v_mul_u32_u24 v5, 20, v4
  v_sub_u32 v5, v3, v5
  v_lshlrev_b32 v5, 4, v5
  v_mul_u32_u24 v4, 1280, v4
  v_add_u32 v17, v4, v5
  v_bfe_u32 v4, v2, 2, 3
  v_lshrrev_b32 v5, 5, v2
  v_lshl_add_u32 v4, v5, 4, v4
  v_mul_u32_u24 v4, 320, v4
  v_and_b32 v5, 3, v2
  v_lshl_add_u32 v4, v5, 3, v4
  v_add_u32 v4, s56, v4
  v_lshlrev_b32 v3, 4, v2
  s_waitcnt lgkmcnt(0)
  s_mov_b32 s8, s84
  s_mov_b32 s9, s85
  s_mov_b32 s10, 2211840
  s_mov_b32 s11, 0x00020000
  s_mov_b32 s28, s90
  s_mov_b32 s29, s91
  s_mov_b32 s30, 256
  s_mov_b32 s31, 0x00020000
  s_add_u32 s4, s92, 20185088
  s_addc_u32 s5, s93, 0
  s_mov_b32 s6, 16384
  s_mov_b32 s7, 0x00020000
  v_mov_b32 v101, 0
  buffer_load_dword v100, v101, s[28:31], 0 offen sc1
  s_waitcnt vmcnt(0)
  s_mov_b32 s58, 4000
L_w2f_non0:
  v_readfirstlane_b32 s59, v100
  s_nop 3
  s_cmp_lg_u32 s59, 0
  s_cbranch_scc1 L_w2f_non0_ok
  s_sub_u32 s58, s58, 1
  s_cmp_eq_u32 s58, 0
  s_cbranch_scc1 L_w2f_non0_ok
  s_sleep 4
  v_mov_b32 v101, 0
  buffer_load_dword v100, v101, s[28:31], 0 offen sc1
  s_waitcnt vmcnt(0)
  s_branch L_w2f_non0
L_w2f_non0_ok:
  s_and_b32 s43, s2, 7
  s_lshl_b32 s43, s43, 7
  s_add_u32 s43, s43, 12288
  v_mov_b32 v102, s43
  buffer_load_dword v103, v102, s[4:7], 0 offen sc1
  s_waitcnt vmcnt(0)
  s_mov_b32 s58, 4000
L_w2f_x:
  v_cmp_eq_u32 vcc, s59, v103
  s_nop 3
  s_cmp_eq_u64 vcc, -1
  s_cbranch_scc1 L_w2f_x_ok
  s_sub_u32 s58, s58, 1
  s_cmp_eq_u32 s58, 0
  s_cbranch_scc1 L_w2f_x_ok
  s_sleep 16
  buffer_load_dword v103, v102, s[4:7], 0 offen sc1
  s_waitcnt vmcnt(0)
  s_branch L_w2f_x
L_w2f_x_ok:
  s_mul_i32 s36, s33, 40960
  s_mul_i32 s37, s34, 320
  s_add_u32 s36, s36, s37
  s_add_u32 m0, s56, 0
  s_nop 0
  buffer_load_dwordx4 v8, s[8:11], s36 offen lds
  s_add_u32 m0, s56, 1024
  s_nop 0
  buffer_load_dwordx4 v9, s[8:11], s36 offen lds
  s_add_u32 m0, s56, 2048
  s_nop 0
  buffer_load_dwordx4 v10, s[8:11], s36 offen lds
  s_add_u32 m0, s56, 3072
  s_nop 0
  buffer_load_dwordx4 v11, s[8:11], s36 offen lds
  s_add_u32 m0, s56, 4096
  s_nop 0
  buffer_load_dwordx4 v12, s[8:11], s36 offen lds
  s_add_u32 m0, s56, 5120
  s_nop 0
  buffer_load_dwordx4 v13, s[8:11], s36 offen lds
  s_add_u32 m0, s56, 6144
  s_nop 0
  buffer_load_dwordx4 v14, s[8:11], s36 offen lds
  s_add_u32 m0, s56, 7168
  s_nop 0
  buffer_load_dwordx4 v15, s[8:11], s36 offen lds
  s_add_u32 m0, s56, 8192
  s_nop 0
  buffer_load_dwordx4 v16, s[8:11], s36 offen lds
  s_add_u32 m0, s56, 9216
  s_nop 0
  buffer_load_dwordx4 v17, s[8:11], s36 offen lds
  s_add_u32 s12, s92, 16777216
  s_addc_u32 s13, s93, 0
  s_mov_b32 s14, 2211840
  s_mov_b32 s15, 0x00020000
  s_mov_b32 s28, s90
  s_mov_b32 s29, s91
  s_mov_b32 s30, 256
  s_mov_b32 s31, 0x00020000
  s_add_u32 s4, s92, 20185088
  s_addc_u32 s5, s93, 0
  s_mov_b32 s6, 16384
  s_mov_b32 s7, 0x00020000
  v_mov_b32 v101, 0
  buffer_load_dword v100, v101, s[28:31], 0 offen sc1
  s_waitcnt vmcnt(0)
  ds_read_b64_tr_b16 v[24:25], v4 offset:0
  ds_read_b64_tr_b16 v[26:27], v4 offset:2560
  ds_read_b64_tr_b16 v[28:29], v4 offset:32
  ds_read_b64_tr_b16 v[30:31], v4 offset:2592
  ds_read_b64_tr_b16 v[32:33], v4 offset:64
  ds_read_b64_tr_b16 v[34:35], v4 offset:2624
  ds_read_b64_tr_b16 v[36:37], v4 offset:96
  ds_read_b64_tr_b16 v[38:39], v4 offset:2656
  ds_read_b64_tr_b16 v[40:41], v4 offset:128
  ds_read_b64_tr_b16 v[42:43], v4 offset:2688
  ds_read_b64_tr_b16 v[44:45], v4 offset:160
  ds_read_b64_tr_b16 v[46:47], v4 offset:2720
  ds_read_b64_tr_b16 v[48:49], v4 offset:192
  ds_read_b64_tr_b16 v[50:51], v4 offset:2752
  ds_read_b64_tr_b16 v[52:53], v4 offset:224
  ds_read_b64_tr_b16 v[54:55], v4 offset:2784
  ds_read_b64_tr_b16 v[56:57], v4 offset:256
  ds_read_b64_tr_b16 v[58:59], v4 offset:2816
  ds_read_b64_tr_b16 v[60:61], v4 offset:288
  ds_read_b64_tr_b16 v[62:63], v4 offset:2848
  s_lshl_b32 s37, s34, 1
  s_mul_i32 s37, s37, 54
  s_add_u32 s37, s37, s33
  s_mul_i32 s37, s37, 5120
  s_waitcnt lgkmcnt(15)
  s_add_u32 s35, s37, 0
  buffer_store_dwordx4 v[24:27], v3, s[12:15], s35 offen sc1
  s_waitcnt lgkmcnt(15)
  s_add_u32 s35, s37, 1024
  buffer_store_dwordx4 v[28:31], v3, s[12:15], s35 offen sc1
  s_waitcnt lgkmcnt(14)
  s_add_u32 s35, s37, 2048
  buffer_store_dwordx4 v[32:35], v3, s[12:15], s35 offen sc1
  s_waitcnt lgkmcnt(12)
  s_add_u32 s35, s37, 3072
  buffer_store_dwordx4 v[36:39], v3, s[12:15], s35 offen sc1
  s_waitcnt lgkmcnt(10)
  s_add_u32 s35, s37, 4096
  buffer_store_dwordx4 v[40:43], v3, s[12:15], s35 offen sc1
  s_waitcnt lgkmcnt(8)
  s_add_u32 s35, s37, 276480
  buffer_store_dwordx4 v[44:47], v3, s[12:15], s35 offen sc1
  s_waitcnt lgkmcnt(6)
  s_add_u32 s35, s37, 277504
  buffer_store_dwordx4 v[48:51], v3, s[12:15], s35 offen sc1
  s_waitcnt lgkmcnt(4)
  s_add_u32 s35, s37, 278528
  buffer_store_dwordx4 v[52:55], v3, s[12:15], s35 offen sc1
  s_waitcnt lgkmcnt(2)
  s_add_u32 s35, s37, 279552
  buffer_store_dwordx4 v[56:59], v3, s[12:15], s35 offen sc1
  s_waitcnt lgkmcnt(0)
  s_add_u32 s35, s37, 280576
  buffer_store_dwordx4 v[60:63], v3, s[12:15], s35 offen sc1
  s_waitcnt vmcnt(0)
  s_mov_b32 s58, 4000
L_w2f_non:
  v_readfirstlane_b32 s59, v100
  s_nop 3
  s_cmp_lg_u32 s59, 0
  s_cbranch_scc1 L_w2f_non_ok
  s_sub_u32 s58, s58, 1
  s_cmp_eq_u32 s58, 0
  s_cbranch_scc1 L_w2f_non_ok
  s_sleep 4
  v_mov_b32 v101, 0
  buffer_load_dword v100, v101, s[28:31], 0 offen sc1
  s_waitcnt vmcnt(0)
  s_branch L_w2f_non
L_w2f_non_ok:
  s_lshl_b32 s38, s34, 8
  s_lshl_b32 s39, s33, 2
  s_add_u32 s38, s38, s39
  s_add_u32 s38, s38, 8192
  v_mov_b32 v3, s38
  v_mov_b32 v5, s59
  s_mov_b64 exec, 1
  buffer_store_dword v5, v3, s[4:7], 0 offen sc1
  s_mov_b64 exec, -1
  s_waitcnt vmcnt(0)
  s_endpgm
L_tlb:
  s_setprio 3
  s_waitcnt lgkmcnt(0)
  s_mov_b32 s8, s92
  s_mov_b32 s9, s93
  s_mov_b32 s10, 20971520
  s_mov_b32 s11, 0x00020000
  v_lshlrev_b32 v3, 21, v2
  v_min_u32 v3, 0x7f000000, v3
  buffer_load_dword v8, v3, s[8:11], 0 offen
  v_and_b32 v4, 1, v2
  v_lshlrev_b32 v4, 21, v4
  s_mov_b32 s12, s88
  s_mov_b32 s13, s89
  s_mov_b32 s14, 2621440
  s_mov_b32 s15, 0x00020000
  buffer_load_dword v9, v4, s[12:15], 0 offen
  s_mov_b32 s12, s84
  s_mov_b32 s13, s85
  s_mov_b32 s14, 2211840
  s_mov_b32 s15, 0x00020000
  buffer_load_dword v10, v4, s[12:15], 0 offen
  s_mov_b32 s12, s64
  s_mov_b32 s13, s65
  s_mov_b32 s14, 2621440
  s_mov_b32 s15, 0x00020000
  buffer_load_dword v11, v4, s[12:15], 0 offen
  s_mov_b32 s12, s80
  s_mov_b32 s13, s81
  s_mov_b32 s14, 2211840
  s_mov_b32 s15, 0x00020000
  buffer_load_dword v12, v4, s[12:15], 0 offen
  s_mov_b32 s12, s82
  s_mov_b32 s13, s83
  s_mov_b32 s14, 3456
  s_mov_b32 s15, 0x00020000
  buffer_load_dword v13, v4, s[12:15], 0 offen
  s_mov_b32 s12, s86
  s_mov_b32 s13, s87
  s_mov_b32 s14, 1280
  s_mov_b32 s15, 0x00020000
  buffer_load_dword v14, v4, s[12:15], 0 offen
  s_mov_b32 s12, s76
  s_mov_b32 s13, s77
  s_mov_b32 s14, 1280
  s_mov_b32 s15, 0x00020000
  buffer_load_dword v15, v4, s[12:15], 0 offen
  s_mov_b32 s12, s90
  s_mov_b32 s13, s91
  s_mov_b32 s14, 256
  s_mov_b32 s15, 0x00020000
  buffer_load_dword v16, v4, s[12:15], 0 offen
  s_mov_b32 s12, s66
  s_mov_b32 s13, s67
  s_mov_b32 s14, 163840
  s_mov_b32 s15, 0x00020000
  buffer_load_dword v17, v4, s[12:15], 0 offen
  s_mov_b32 s12, s68
  s_mov_b32 s13, s69
  s_mov_b32 s14, 163840
  s_mov_b32 s15, 0x00020000
  buffer_load_dword v18, v4, s[12:15], 0 offen
  s_mov_b32 s12, s70
  s_mov_b32 s13, s71
  s_mov_b32 s14, 163840
  s_mov_b32 s15, 0x00020000
  buffer_load_dword v19, v4, s[12:15], 0 offen
  s_mov_b32 s12, s72
  s_mov_b32 s13, s73
  s_mov_b32 s14, 163840
  s_mov_b32 s15, 0x00020000
  buffer_load_dword v20, v4, s[12:15], 0 offen
  s_mov_b32 s12, s74
  s_mov_b32 s13, s75
  s_mov_b32 s14, 1280
  s_mov_b32 s15, 0x00020000
  buffer_load_dword v21, v4, s[12:15], 0 offen
  s_waitcnt vmcnt(0)
  s_waitcnt vmcnt(0)
  s_endpgm
L_exit:
  s_endpgm
.section .rodata,"a"
.p2align 6
.amdhsa_kernel recurrent_scan__ssm_conv_s4d__dense_activation_gelu__prompt_kernel
  .amdhsa_next_free_vgpr 256
  .amdhsa_next_free_sgpr 102
  .amdhsa_accum_offset 256
  .amdhsa_group_segment_fixed_size 0
  .amdhsa_kernarg_size 120
  .amdhsa_user_sgpr_count 2
  .amdhsa_user_sgpr_kernarg_segment_ptr 1
  .amdhsa_system_sgpr_workgroup_id_x 1
  .amdhsa_float_denorm_mode_32 3
.end_amdhsa_kernel
```
